```python
import torch

def _softmax(x, axis=-1):
    return torch.softmax(x, dim=axis)
def _gelu(x):
    return torch.nn.functional.gelu(x, approximate="tanh")
def _silu(x):
    return torch.nn.functional.silu(x)
def _sigmoid(x):
    return torch.sigmoid(x)
def _layernorm(x, axis=-1, eps=1e-5):
    m = x.mean(dim=axis, keepdim=True)
    v = x.var(dim=axis, keepdim=True, unbiased=False)
    return (x - m) / torch.sqrt(v + eps)
def _scatter_add(tgt, idx, src, axis=0):
    return tgt.clone().index_add_(axis, idx, src)
def _segment_sum(src, seg, n):
    out = torch.zeros((n,) + src.shape[1:], dtype=src.dtype)
    return out.index_add_(0, seg, src)
def _pad(x, pw):
    flat = tuple(v for pair in reversed(pw) for v in pair)
    return torch.nn.functional.pad(x, flat)

kernel_name = 'sequential_preLN__ssm_conv_s4d__mixer_channel_mlp__prompt'

def setup_inputs():

    _w = (lambda a: (lambda t: t.to(torch.bfloat16) if t.is_floating_point() else t)(torch.as_tensor(a)))
    def _A_setup():
        Bsz, L, D, N = 1, 2048, 448, 256
        return {
            "u": _w((lambda *s: torch.randn(*s, dtype=torch.bfloat16) * 0.05)(Bsz, L, D)),
            "log_A_real": _w((lambda *s: torch.randn(*s, dtype=torch.bfloat16) * 3.2)(D, N) * 0.5),
            "A_imag": _w((lambda *s: torch.randn(*s, dtype=torch.bfloat16) * 0.05)(D, N) * 3.14),
            "C_real": _w((lambda *s: torch.randn(*s, dtype=torch.bfloat16) * 0.1)(D, N) / N ** 0.5),
            "C_imag": _w((lambda *s: torch.randn(*s, dtype=torch.bfloat16) * 0.1)(D, N) / N ** 0.5),
            "log_dt": _w((lambda *s: torch.randn(*s, dtype=torch.bfloat16) * 0.05)(D) * 0.5 - 4.0),
            "D_skip": _w((lambda *s: torch.randn(*s, dtype=torch.bfloat16) * 0.05)(D)),
        }
    _A_in = _A_setup()

    def _B_setup():
        B, S, D, F = 1, 2048, 448, 1792
        return {
            "x": _w((lambda *s: torch.randn(*s, dtype=torch.bfloat16) * 0.05)(B, S, D)),
            "w1": _w((lambda *s: torch.randn(*s, dtype=torch.bfloat16) * 1.6)(D, F) * (D ** -0.5)),
            "b1": _w((lambda *s: torch.randn(*s, dtype=torch.bfloat16) * 0.8)(F)),
            "w2": _w((lambda *s: torch.randn(*s, dtype=torch.bfloat16) * 0.05)(F, D) * (F ** -0.5)),
            "b2": _w((lambda *s: torch.randn(*s, dtype=torch.bfloat16) * 0.05)(D)),
        }
    _B_in = _B_setup()

    return {
        "A_u": _A_in["u"],
        "A_log_A_real": _A_in["log_A_real"],
        "A_A_imag": _A_in["A_imag"],
        "A_C_real": _A_in["C_real"],
        "A_C_imag": _A_in["C_imag"],
        "A_log_dt": _A_in["log_dt"],
        "A_D_skip": _A_in["D_skip"],
        "B_x": _B_in["x"],
        "B_w1": _B_in["w1"],
        "B_b1": _B_in["b1"],
        "B_w2": _B_in["w2"],
        "B_b2": _B_in["b2"],
    }

def reference(A_u, A_log_A_real, A_A_imag, A_C_real, A_C_imag, A_log_dt, A_D_skip, B_x, B_w1, B_b1, B_w2, B_b2):
    def _A_ref(u, log_A_real, A_imag, C_real, C_imag, log_dt, D_skip):
        L = u.shape[1]
        dt = torch.exp(log_dt)
        A = -torch.exp(log_A_real) + 1j * A_imag
        C = (C_real + 1j * C_imag) * dt[:, None]
        pos = (lambda x, dt: x.to(dt))(torch.arange(L), log_dt.dtype)
        P = torch.exp((A * dt[:, None])[:, :, None] * pos[None, None, :])
        K = 2.0 * torch.einsum("dn,dnl->dl", C, P).real
        L2 = 2 * L
        u_t = (lambda x, *d: x.permute(*d))(u, 0, 2, 1)
        Kf = (lambda x, *a, **k: torch.fft.rfft(x.float(), *a, **k))(K, L2)
        Uf = (lambda x, *a, **k: torch.fft.rfft(x.float(), *a, **k))(u_t, L2)
        y = (lambda x, *a, **k: torch.fft.irfft(x, *a, **k).to(torch.bfloat16))(Uf * Kf[None, :, :], L2)[:, :, :L]
        y = (lambda x, *d: x.permute(*d))(y, 0, 2, 1)
        return y + u * D_skip[None, None, :]

    def _B_ref(x, w1, b1, w2, b2):
        y = _layernorm(x, axis=-1)
        h = _gelu(torch.einsum("bsd,df->bsf", y, w1) + b1)
        return torch.einsum("bsf,fd->bsd", h, w2) + b2

    x = A_u
    h = x + _A_ref(_layernorm(x, axis=-1), A_log_A_real, A_A_imag, A_C_real, A_C_imag, A_log_dt, A_D_skip)
    h2 = h + _B_ref(_layernorm(h, axis=-1), B_w1, B_b1, B_w2, B_b2)
    return h2
```

```asm
; @launch grid=(256,1,1) block=(256,1,1) lds=163840
.amdgcn_target "amdgcn-amd-amdhsa--gfx950"
.text
.globl sequential_preLN__ssm_conv_s4d__mixer_channel_mlp__prompt_kernel
.p2align 8
.type sequential_preLN__ssm_conv_s4d__mixer_channel_mlp__prompt_kernel,@function
sequential_preLN__ssm_conv_s4d__mixer_channel_mlp__prompt_kernel:
s_cmp_ge_u32 s2, 256
s_cbranch_scc1 L_end
s_load_dwordx16 s[4:19], s[0:1], 0
s_load_dwordx2 s[32:33], s[0:1], 112
s_load_dwordx8 s[20:27], s[0:1], 64
s_load_dwordx4 s[28:31], s[0:1], 96
s_getpc_b64 s[60:61]
L_pc:
v_lshlrev_b32 v2, 7, v0
v_min_u32 v2, L_end-L_pc, v2
v_mov_b32 v9, s61
v_add_co_u32 v8, vcc, s60, v2
v_and_b32 v1, 63, v0
v_lshrrev_b32 v2, 6, v0
v_addc_co_u32 v9, vcc, 0, v9, vcc
global_load_dword v39, v[8:9], off
v_readfirstlane_b32 s34, v2
s_and_b32 s3, s2, 7
s_lshr_b32 s69, s2, 3
s_mul_i32 s60, s69, 37
s_lshr_b32 s60, s60, 8
s_mul_i32 s61, s60, 7
s_sub_u32 s59, s69, s61
s_lshl_b32 s58, s3, 2
s_add_u32 s58, s58, s60
s_mul_i32 s57, s3, 28
s_min_u32 s60, s69, 27
s_add_u32 s57, s57, s60
s_mov_b32 s62, 0x3f803f80
s_mov_b32 s65, 0xffff0000
s_mul_i32 s70, s2, 7168
v_and_b32 v44, 7, v0
v_lshrrev_b32 v45, 3, v0
v_mul_u32_u24 v91, 1792, v44
v_lshl_add_u32 v91, v45, 4, v91
s_lshr_b32 s82, s2, 1
s_mul_i32 s82, s82, 14336
s_and_b32 s60, s2, 1
s_mul_i32 s60, s60, 448
s_add_u32 s82, s82, s60
v_mul_u32_u24 v92, 28, v0
v_lshlrev_b32 v11, 4, v0
v_add_u32 v93, 0x1000, v11
v_mov_b32 v48, 33554432
v_cmp_gt_u32 vcc, 192, v0
v_mov_b32 v52, -1
v_mov_b32 v53, -1
v_cndmask_b32 v93, v48, v93, vcc
v_mov_b32 v54, -1
v_mov_b32 v55, -1
v_mov_b32 v50, 0
s_lshl_b32 s60, s57, 10
v_lshl_add_u32 v94, v0, 2, s60
s_lshl_b32 s60, s57, 2
s_mov_b32 s38, 33554432
s_mov_b32 s39, 0x20000
s_mov_b32 s54, 1835008
s_mov_b32 s55, 0x20000
s_add_u32 s76, s70, 4194304

s_waitcnt lgkmcnt(0)
global_load_dword v40, v94, s[6:7]
global_load_dword v41, v94, s[8:9]
s_load_dword s63, s[14:15], s60
s_load_dword s64, s[16:17], s60
s_mov_b32 s36, s32
s_and_b32 s37, s33, 0xffff
s_mov_b32 s52, s4
s_and_b32 s53, s5, 0xffff
s_load_dword s35, s[32:33], 0
s_barrier
buffer_load_dwordx4 v[112:115], v91, s[52:55], s82 offen
buffer_load_dwordx4 v[124:127], v91, s[52:55], s82 offen offset:896
buffer_load_dwordx4 v[32:35], v92, s[52:55], s70 offen
buffer_load_dwordx3 v[36:38], v92, s[52:55], s70 offen offset:16
s_mov_b32 s40, s20
s_and_b32 s41, s21, 0xffff
s_mov_b32 s42, 1605632
s_mov_b32 s43, 0x00020000
s_mov_b32 s44, s24
s_and_b32 s45, s25, 0xffff
s_mov_b32 s46, 1605632
s_mov_b32 s47, 0x00020000
s_mov_b32 s48, s28
s_and_b32 s49, s29, 0xffff
s_mov_b32 s50, 1835008
s_mov_b32 s51, 0x00020000
v_mul_u32_u24 v8, 66560, v45
v_cmp_gt_u32 vcc, 28, v45
v_lshl_add_u32 v8, v44, 4, v8
s_and_b32 s74, s2, 1
s_mul_i32 s74, s74, 1863616
s_lshl_b32 s60, s2, 6
s_add_u32 s74, s74, s60
s_lshl_b32 s66, s59, 2
s_add_u32 s66, s66, s34
v_cndmask_b32 v8, v48, v8, vcc

s_cmp_ge_u32 s69, 28
s_cbranch_scc1 L_helper
s_mul_i32 s77, s57, 7168
v_cmp_gt_u32 vcc, 224, v0
v_lshlrev_b32 v7, 5, v0
v_and_b32 v7, 0x1f80, v7
v_cndmask_b32 v83, v48, v7, vcc
v_lshrrev_b32 v3, 3, v1
v_mul_u32_u24 v3, 3584, v3
v_lshrrev_b32 v7, 2, v1
v_and_b32 v7, 4, v7
v_xor_b32 v7, v7, v1
v_and_b32 v7, 7, v7
v_lshl_add_u32 v3, v7, 4, v3
v_add_u32 v12, 27648, v3
v_add_u32 v13, 55296, v3
v_add_u32 v14, 82944, v3
s_lshl_b32 s66, s66, 7
s_mul_i32 s67, s34, 14336
s_add_u32 s67, s67, 75008
s_mul_i32 s73, s58, 7
s_add_u32 s73, s73, s59
s_lshl_b32 s73, s73, 2
s_add_u32 s73, s73, s34
s_mul_i32 s73, s73, 13312
s_add_u32 s73, s73, 6291456
v_lshlrev_b32 v10, 4, v1
v_lshrrev_b32 v7, 5, v1
v_bfe_u32 v44, v1, 2, 2
v_lshl_add_u32 v45, v7, 3, v44
v_lshlrev_b32 v4, 7, v45
v_bfe_u32 v44, v1, 3, 1
v_lshl_add_u32 v4, v44, 6, v4
v_bfe_u32 v44, v1, 4, 1
v_lshl_add_u32 v4, v44, 5, v4
v_and_b32 v44, 3, v1
v_lshl_add_u32 v4, v44, 3, v4
v_xor_b32 v5, 64, v4
v_add_u32 v4, s67, v4
v_add_u32 v5, s67, v5
s_lshr_b32 s61, s34, 1
s_mul_i32 s71, s61, 42496
s_mul_i32 s72, s34, 16896
s_mul_i32 s61, s61, 8704
s_add_u32 s61, s61, s72
v_and_b32 v44, 31, v1
v_lshl_add_u32 v6, v7, 7, v44
v_lshl_add_u32 v6, v6, 2, s61
v_mul_u32_u24 v44, 528, v44
v_lshl_add_u32 v7, v7, 4, v44
v_add_u32 v7, s72, v7
v_mov_b32 v51, 0
v_bfe_u32 v44, v0, 6, 1
v_mul_u32_u24 v44, 4608, v44
v_lshl_add_u32 v44, v1, 3, v44
v_add_u32 v44, 148992, v44
ds_write_b64 v44, v[50:51]
v_and_b32 v44, 127, v0
v_cmp_eq_u32 s[80:81], 0, v44
v_sub_u32 v81, 127, v44
s_cmp_ge_u32 s34, 2
s_cselect_b32 s75, 25088, 0
s_cselect_b32 s61, 0, 132352
s_or_b32 s75, s75, s61
v_lshl_add_u32 v81, v81, 5, s75
v_lshlrev_b32 v44, 4, v44
v_cvt_f32_u32 v45, v44
s_movk_i32 s61, 0xf00
v_add_f32 v46, 0xbf800000, v45
v_add_f32 v47, 0x00000000, v45
v_cvt_pk_bf16_f32 v46, v46, v47
v_and_b32 v47, s65, v46
v_lshlrev_b32 v46, 16, v46
v_cvt_u32_f32 v46, v46
v_bfe_u32 v49, v46, 3, 5
v_and_or_b32 v49, v46, s61, v49
v_bfe_u32 v44, v46, 8, 1
v_xor_b32 v49, v49, v44
v_and_b32 v46, 7, v46
v_lshl_add_u32 v49, v46, 5, v49
v_lshl_add_u32 v64, v49, 2, s71
v_cvt_u32_f32 v47, v47
v_bfe_u32 v49, v47, 3, 5
v_and_or_b32 v49, v47, s61, v49
v_bfe_u32 v44, v47, 8, 1
v_xor_b32 v49, v49, v44
v_and_b32 v47, 7, v47
v_lshl_add_u32 v49, v47, 5, v49
v_lshl_add_u32 v65, v49, 2, s71
v_add_f32 v46, 0x3f800000, v45
v_add_f32 v47, 0x40000000, v45
v_cvt_pk_bf16_f32 v46, v46, v47
v_and_b32 v47, s65, v46
v_lshlrev_b32 v46, 16, v46
v_cvt_u32_f32 v46, v46
v_bfe_u32 v49, v46, 3, 5
v_and_or_b32 v49, v46, s61, v49
v_bfe_u32 v44, v46, 8, 1
v_xor_b32 v49, v49, v44
v_and_b32 v46, 7, v46
v_lshl_add_u32 v49, v46, 5, v49
v_lshl_add_u32 v66, v49, 2, s71
v_cvt_u32_f32 v47, v47
v_bfe_u32 v49, v47, 3, 5
v_and_or_b32 v49, v47, s61, v49
v_bfe_u32 v44, v47, 8, 1
v_xor_b32 v49, v49, v44
v_and_b32 v47, 7, v47
v_lshl_add_u32 v49, v47, 5, v49
v_lshl_add_u32 v67, v49, 2, s71
v_add_f32 v46, 0x40400000, v45
v_add_f32 v47, 0x40800000, v45
v_cvt_pk_bf16_f32 v46, v46, v47
v_and_b32 v47, s65, v46
v_lshlrev_b32 v46, 16, v46
v_cvt_u32_f32 v46, v46
v_bfe_u32 v49, v46, 3, 5
v_and_or_b32 v49, v46, s61, v49
v_bfe_u32 v44, v46, 8, 1
v_xor_b32 v49, v49, v44
v_and_b32 v46, 7, v46
v_lshl_add_u32 v49, v46, 5, v49
v_lshl_add_u32 v68, v49, 2, s71
v_cvt_u32_f32 v47, v47
v_bfe_u32 v49, v47, 3, 5
v_and_or_b32 v49, v47, s61, v49
v_bfe_u32 v44, v47, 8, 1
v_xor_b32 v49, v49, v44
v_and_b32 v47, 7, v47
v_lshl_add_u32 v49, v47, 5, v49
v_lshl_add_u32 v69, v49, 2, s71
v_add_f32 v46, 0x40a00000, v45
v_add_f32 v47, 0x40c00000, v45
v_cvt_pk_bf16_f32 v46, v46, v47
v_and_b32 v47, s65, v46
v_lshlrev_b32 v46, 16, v46
v_cvt_u32_f32 v46, v46
v_bfe_u32 v49, v46, 3, 5
v_and_or_b32 v49, v46, s61, v49
v_bfe_u32 v44, v46, 8, 1
v_xor_b32 v49, v49, v44
v_and_b32 v46, 7, v46
v_lshl_add_u32 v49, v46, 5, v49
v_lshl_add_u32 v70, v49, 2, s71
v_cvt_u32_f32 v47, v47
v_bfe_u32 v49, v47, 3, 5
v_and_or_b32 v49, v47, s61, v49
v_bfe_u32 v44, v47, 8, 1
v_xor_b32 v49, v49, v44
v_and_b32 v47, 7, v47
v_lshl_add_u32 v49, v47, 5, v49
v_lshl_add_u32 v71, v49, 2, s71
v_add_f32 v46, 0x40e00000, v45
v_add_f32 v47, 0x41000000, v45
v_cvt_pk_bf16_f32 v46, v46, v47
v_and_b32 v47, s65, v46
v_lshlrev_b32 v46, 16, v46
v_cvt_u32_f32 v46, v46
v_bfe_u32 v49, v46, 3, 5
v_and_or_b32 v49, v46, s61, v49
v_bfe_u32 v44, v46, 8, 1
v_xor_b32 v49, v49, v44
v_and_b32 v46, 7, v46
v_lshl_add_u32 v49, v46, 5, v49
v_lshl_add_u32 v72, v49, 2, s71
v_cvt_u32_f32 v47, v47
v_bfe_u32 v49, v47, 3, 5
v_and_or_b32 v49, v47, s61, v49
v_bfe_u32 v44, v47, 8, 1
v_xor_b32 v49, v49, v44
v_and_b32 v47, 7, v47
v_lshl_add_u32 v49, v47, 5, v49
v_lshl_add_u32 v73, v49, 2, s71
v_add_f32 v46, 0x41100000, v45
v_add_f32 v47, 0x41200000, v45
v_cvt_pk_bf16_f32 v46, v46, v47
v_and_b32 v47, s65, v46
v_lshlrev_b32 v46, 16, v46
v_cvt_u32_f32 v46, v46
v_bfe_u32 v49, v46, 3, 5
v_and_or_b32 v49, v46, s61, v49
v_bfe_u32 v44, v46, 8, 1
v_xor_b32 v49, v49, v44
v_and_b32 v46, 7, v46
v_lshl_add_u32 v49, v46, 5, v49
v_lshl_add_u32 v74, v49, 2, s71
v_cvt_u32_f32 v47, v47
v_bfe_u32 v49, v47, 3, 5
v_and_or_b32 v49, v47, s61, v49
v_bfe_u32 v44, v47, 8, 1
v_xor_b32 v49, v49, v44
v_and_b32 v47, 7, v47
v_lshl_add_u32 v49, v47, 5, v49
v_lshl_add_u32 v75, v49, 2, s71
v_add_f32 v46, 0x41300000, v45
v_add_f32 v47, 0x41400000, v45
v_cvt_pk_bf16_f32 v46, v46, v47
v_and_b32 v47, s65, v46
v_lshlrev_b32 v46, 16, v46
v_cvt_u32_f32 v46, v46
v_bfe_u32 v49, v46, 3, 5
v_and_or_b32 v49, v46, s61, v49
v_bfe_u32 v44, v46, 8, 1
v_xor_b32 v49, v49, v44
v_and_b32 v46, 7, v46
v_lshl_add_u32 v49, v46, 5, v49
v_lshl_add_u32 v76, v49, 2, s71
v_cvt_u32_f32 v47, v47
v_bfe_u32 v49, v47, 3, 5
v_and_or_b32 v49, v47, s61, v49
v_bfe_u32 v44, v47, 8, 1
v_xor_b32 v49, v49, v44
v_and_b32 v47, 7, v47
v_lshl_add_u32 v49, v47, 5, v49
v_min_u32 v49, 1824, v49
v_lshl_add_u32 v77, v49, 2, s71
v_add_f32 v46, 0x41500000, v45
v_add_f32 v47, 0x41600000, v45
v_cvt_pk_bf16_f32 v46, v46, v47
v_and_b32 v47, s65, v46
v_lshlrev_b32 v46, 16, v46
v_cvt_u32_f32 v46, v46
v_bfe_u32 v49, v46, 3, 5
v_and_or_b32 v49, v46, s61, v49
v_bfe_u32 v44, v46, 8, 1
v_xor_b32 v49, v49, v44
v_and_b32 v46, 7, v46
v_lshl_add_u32 v49, v46, 5, v49
v_min_u32 v49, 1824, v49
v_lshl_add_u32 v78, v49, 2, s71
v_cvt_u32_f32 v47, v47
v_bfe_u32 v49, v47, 3, 5
v_and_or_b32 v49, v47, s61, v49
v_bfe_u32 v44, v47, 8, 1
v_xor_b32 v49, v49, v44
v_and_b32 v47, 7, v47
v_lshl_add_u32 v49, v47, 5, v49
v_min_u32 v49, 1824, v49
v_lshl_add_u32 v79, v49, 2, s71
v_add_f32 v46, 0x41700000, v45
v_add_f32 v47, 0x41800000, v45
v_cvt_pk_bf16_f32 v46, v46, v47
v_and_b32 v47, s65, v46
v_lshlrev_b32 v46, 16, v46
v_cvt_u32_f32 v46, v46
v_bfe_u32 v49, v46, 3, 5
v_and_or_b32 v49, v46, s61, v49
v_bfe_u32 v44, v46, 8, 1
v_xor_b32 v49, v49, v44
v_and_b32 v46, 7, v46
v_lshl_add_u32 v49, v46, 5, v49
v_min_u32 v49, 1824, v49
v_lshl_add_u32 v80, v49, 2, s71
buffer_store_dwordx4 v[52:55], v11, s[36:39], s76 offen sc1
buffer_store_dwordx4 v[52:55], v93, s[36:39], s76 offen sc1
s_lshr_b32 s60, s34, 1
s_lshl_b32 s60, s60, 4
s_waitcnt lgkmcnt(0)
s_lshr_b32 s63, s63, s60
s_lshl_b32 s63, s63, 16
s_lshr_b32 s64, s64, s60
s_lshl_b32 s64, s64, 16
v_mov_b32 v44, 0x3fb8aa3b
v_mul_f32 v45, s63, v44
v_exp_f32 v45, v45
v_mov_b32 v82, s64
v_cndmask_b32 v82, 0, v82, s[80:81]
v_cvt_pk_bf16_f32 v45, v45, v45
v_and_b32 v45, s65, v45
v_mov_b32 v56, s62
v_mov_b32 v57, 0
s_waitcnt vmcnt(7)
v_lshlrev_b32 v46, 16, v40
v_and_b32 v47, s65, v40
v_mul_f32 v46, v44, v46
v_mul_f32 v47, v44, v47
v_exp_f32 v46, v46
v_exp_f32 v47, v47
s_waitcnt vmcnt(6)
v_lshlrev_b32 v48, 16, v41
v_cvt_pk_bf16_f32 v46, v46, v47
v_and_b32 v47, s65, v46
v_lshlrev_b32 v46, 16, v46
v_and_b32 v49, s65, v41
v_pk_mul_f32 v[46:47], v[46:47], v[44:45] op_sel:[0,1] op_sel_hi:[1,1]
v_pk_mul_f32 v[48:49], v[48:49], v[44:45] op_sel:[0,1] op_sel_hi:[1,1]
v_pk_mul_f32 v[46:47], v[46:47], v[44:45] op_sel_hi:[1,0] neg_lo:[0,1] neg_hi:[0,1]
v_mul_f32 v48, 0.15915494, v48
v_mul_f32 v49, 0.15915494, v49
v_mul_f32 v120, 0x41000000, v46
v_mul_f32 v122, 0x41000000, v48
v_exp_f32 v120, v120
v_fract_f32 v122, v122
v_mul_f32 v121, 0x41000000, v47
v_mul_f32 v123, 0x41000000, v49
v_exp_f32 v121, v121
v_fract_f32 v123, v123
v_cos_f32 v84, v122
v_cos_f32 v85, v123
v_sin_f32 v86, v122
v_sin_f32 v87, v123
v_pk_mul_f32 v[84:85], v[84:85], v[120:121]
v_pk_mul_f32 v[86:87], v[86:87], v[120:121]
v_cvt_pk_bf16_f32 v59, v86, v87
v_cvt_pk_bf16_f32 v58, v84, v85
v_pk_mul_f32 v[120:121], v[84:85], v[84:85]
v_pk_mul_f32 v[122:123], v[86:87], v[84:85]
v_pk_fma_f32 v[98:99], v[84:85], v[86:87], v[122:123]
v_pk_fma_f32 v[96:97], v[86:87], v[86:87], v[120:121] neg_lo:[1,0,0] neg_hi:[1,0,0]
v_cvt_pk_bf16_f32 v61, v98, v99
v_cvt_pk_bf16_f32 v60, v96, v97
v_pk_mul_f32 v[120:121], v[96:97], v[84:85]
v_pk_mul_f32 v[122:123], v[98:99], v[84:85]
v_pk_fma_f32 v[102:103], v[96:97], v[86:87], v[122:123]
v_pk_fma_f32 v[100:101], v[98:99], v[86:87], v[120:121] neg_lo:[1,0,0] neg_hi:[1,0,0]
v_cvt_pk_bf16_f32 v63, v102, v103
s_mov_b32 m0, s72
v_cvt_pk_bf16_f32 v62, v100, v101
ds_write_addtid_b32 v57 offset:256
ds_write_addtid_b32 v56 offset:0
ds_write_addtid_b32 v59 offset:784
ds_write_addtid_b32 v58 offset:528
ds_write_addtid_b32 v61 offset:1312
ds_write_addtid_b32 v60 offset:1056
ds_write_addtid_b32 v63 offset:1840
ds_write_addtid_b32 v62 offset:1584
global_load_dword v42, v94, s[10:11]
global_load_dword v43, v94, s[12:13]
buffer_load_dword v119, v83, s[40:43], s77 offen
s_add_u32 s35, s35, 1
v_mov_b32 v2, s35
v_pk_mov_b32 v[18:19], v[2:3], v[2:3] op_sel:[0,0]
v_pk_mov_b32 v[22:23], v[2:3], v[2:3] op_sel:[0,0]
v_pk_mov_b32 v[26:27], v[2:3], v[2:3] op_sel:[0,0]
v_pk_mov_b32 v[30:31], v[2:3], v[2:3] op_sel:[0,0]
s_waitcnt vmcnt(7)
v_pk_mov_b32 v[16:17], v[112:113], v[124:125] op_sel:[0,0]
v_pk_mov_b32 v[20:21], v[112:113], v[124:125] op_sel:[1,1]
v_pk_mov_b32 v[24:25], v[114:115], v[126:127] op_sel:[0,0]
v_pk_mov_b32 v[28:29], v[114:115], v[126:127] op_sel:[1,1]
s_add_u32 s60, s74, 65536
buffer_store_dwordx4 v[16:19], v8, s[36:39], s60 offen sc1
s_add_u32 s60, s74, 82176
buffer_store_dwordx4 v[20:23], v8, s[36:39], s60 offen sc1
s_add_u32 s60, s74, 98816
buffer_store_dwordx4 v[24:27], v8, s[36:39], s60 offen sc1
s_add_u32 s60, s74, 115456
buffer_store_dwordx4 v[28:31], v8, s[36:39], s60 offen sc1
v_pk_mul_f32 v[120:121], v[100:101], v[84:85]
v_pk_mul_f32 v[122:123], v[102:103], v[84:85]
v_pk_fma_f32 v[98:99], v[100:101], v[86:87], v[122:123]
v_pk_fma_f32 v[96:97], v[102:103], v[86:87], v[120:121] neg_lo:[1,0,0] neg_hi:[1,0,0]
v_cvt_pk_bf16_f32 v57, v98, v99
v_cvt_pk_bf16_f32 v56, v96, v97
v_pk_mul_f32 v[120:121], v[96:97], v[84:85]
v_pk_mul_f32 v[122:123], v[98:99], v[84:85]
v_pk_fma_f32 v[102:103], v[96:97], v[86:87], v[122:123]
v_pk_fma_f32 v[100:101], v[98:99], v[86:87], v[120:121] neg_lo:[1,0,0] neg_hi:[1,0,0]
v_cvt_pk_bf16_f32 v59, v102, v103
v_cvt_pk_bf16_f32 v58, v100, v101
v_pk_mul_f32 v[120:121], v[100:101], v[84:85]
v_pk_mul_f32 v[122:123], v[102:103], v[84:85]
v_pk_fma_f32 v[98:99], v[100:101], v[86:87], v[122:123]
v_pk_fma_f32 v[96:97], v[102:103], v[86:87], v[120:121] neg_lo:[1,0,0] neg_hi:[1,0,0]
v_cvt_pk_bf16_f32 v61, v98, v99
v_cvt_pk_bf16_f32 v60, v96, v97
v_pk_mul_f32 v[120:121], v[96:97], v[84:85]
v_pk_mul_f32 v[122:123], v[98:99], v[84:85]
v_pk_fma_f32 v[102:103], v[96:97], v[86:87], v[122:123]
v_pk_fma_f32 v[100:101], v[98:99], v[86:87], v[120:121] neg_lo:[1,0,0] neg_hi:[1,0,0]
v_cvt_pk_bf16_f32 v63, v102, v103
s_mov_b32 m0, s72
v_cvt_pk_bf16_f32 v62, v100, v101
ds_write_addtid_b32 v57 offset:2368
ds_write_addtid_b32 v56 offset:2112
ds_write_addtid_b32 v59 offset:2896
ds_write_addtid_b32 v58 offset:2640
ds_write_addtid_b32 v61 offset:3424
ds_write_addtid_b32 v60 offset:3168
ds_write_addtid_b32 v63 offset:3952
ds_write_addtid_b32 v62 offset:3696
v_pk_mul_f32 v[120:121], v[100:101], v[84:85]
v_pk_mul_f32 v[122:123], v[102:103], v[84:85]
v_pk_fma_f32 v[98:99], v[100:101], v[86:87], v[122:123]
v_pk_fma_f32 v[96:97], v[102:103], v[86:87], v[120:121] neg_lo:[1,0,0] neg_hi:[1,0,0]
v_cvt_pk_bf16_f32 v57, v98, v99
v_cvt_pk_bf16_f32 v56, v96, v97
v_pk_mul_f32 v[120:121], v[96:97], v[84:85]
v_pk_mul_f32 v[122:123], v[98:99], v[84:85]
v_pk_fma_f32 v[102:103], v[96:97], v[86:87], v[122:123]
v_pk_fma_f32 v[100:101], v[98:99], v[86:87], v[120:121] neg_lo:[1,0,0] neg_hi:[1,0,0]
v_cvt_pk_bf16_f32 v59, v102, v103
v_cvt_pk_bf16_f32 v58, v100, v101
v_pk_mul_f32 v[120:121], v[100:101], v[84:85]
v_pk_mul_f32 v[122:123], v[102:103], v[84:85]
v_pk_fma_f32 v[98:99], v[100:101], v[86:87], v[122:123]
v_pk_fma_f32 v[96:97], v[102:103], v[86:87], v[120:121] neg_lo:[1,0,0] neg_hi:[1,0,0]
v_cvt_pk_bf16_f32 v61, v98, v99
v_cvt_pk_bf16_f32 v60, v96, v97
v_pk_mul_f32 v[120:121], v[96:97], v[84:85]
v_pk_mul_f32 v[122:123], v[98:99], v[84:85]
v_pk_fma_f32 v[102:103], v[96:97], v[86:87], v[122:123]
v_pk_fma_f32 v[100:101], v[98:99], v[86:87], v[120:121] neg_lo:[1,0,0] neg_hi:[1,0,0]
v_cvt_pk_bf16_f32 v63, v102, v103
s_mov_b32 m0, s72
v_cvt_pk_bf16_f32 v62, v100, v101
ds_write_addtid_b32 v57 offset:4480
ds_write_addtid_b32 v56 offset:4224
ds_write_addtid_b32 v59 offset:5008
ds_write_addtid_b32 v58 offset:4752
ds_write_addtid_b32 v61 offset:5536
ds_write_addtid_b32 v60 offset:5280
ds_write_addtid_b32 v63 offset:6064
ds_write_addtid_b32 v62 offset:5808
s_lshl_b32 s61, s2, 6
s_waitcnt vmcnt(10)
v_dot2_f32_bf16 v116, v32, s62, 0
v_dot2_f32_bf16 v117, v32, v32, 0
v_dot2_f32_bf16 v116, v33, s62, v116
v_dot2_f32_bf16 v117, v33, v33, v117
v_dot2_f32_bf16 v116, v34, s62, v116
v_dot2_f32_bf16 v117, v34, v34, v117
v_dot2_f32_bf16 v116, v35, s62, v116
v_dot2_f32_bf16 v117, v35, v35, v117
s_waitcnt vmcnt(9)
v_dot2_f32_bf16 v116, v36, s62, v116
v_dot2_f32_bf16 v117, v36, v36, v117
v_dot2_f32_bf16 v116, v37, s62, v116
v_dot2_f32_bf16 v117, v37, v37, v117
v_dot2_f32_bf16 v116, v38, s62, v116
v_dot2_f32_bf16 v117, v38, v38, v117
s_nop 1
v_add_f32_dpp v116, v116, v116 quad_perm:[1,0,3,2] row_mask:0xf bank_mask:0xf
v_add_f32_dpp v117, v117, v117 quad_perm:[1,0,3,2] row_mask:0xf bank_mask:0xf
s_lshl_b32 s60, s34, 4
v_add_f32_dpp v116, v116, v116 quad_perm:[2,3,0,1] row_mask:0xf bank_mask:0xf
v_add_f32_dpp v117, v117, v117 quad_perm:[2,3,0,1] row_mask:0xf bank_mask:0xf
s_add_u32 s60, s60, s61
v_add_f32_dpp v116, v116, v116 row_half_mirror row_mask:0xf bank_mask:0xf
v_add_f32_dpp v117, v117, v117 row_half_mirror row_mask:0xf bank_mask:0xf
s_add_u32 s60, s60, 4096
v_add_f32_dpp v116, v116, v116 row_mirror row_mask:0xf bank_mask:0xf
v_add_f32_dpp v117, v117, v117 row_mirror row_mask:0xf bank_mask:0xf
v_mov_b32 v35, v2
v_pk_mov_b32 v[32:33], v[116:117], v[116:117] op_sel:[0,1]
v_lshlrev_b32 v118, 25, v1
s_nop 0
v_permlane16_swap_b32 v32, v116
v_permlane16_swap_b32 v33, v117
v_pk_add_f32 v[116:117], v[116:117], v[32:33]
v_mul_f32 v116, 0x3b124925, v116
v_mul_f32 v117, 0x3b124925, v117
v_fma_f32 v117, -v116, v116, v117
v_max_f32 v117, 0, v117
v_cvt_pk_bf16_f32 v34, v116, v117
v_and_b32 v117, s65, v34
v_add_f32 v117, 0x3727c5ac, v117
v_cvt_pk_bf16_f32 v117, v117, v117
v_and_b32 v117, s65, v117
v_sqrt_f32 v117, v117
v_mov_b32 v116, v34
v_cvt_pk_bf16_f32 v117, v117, v117
v_and_b32 v117, s65, v117
v_rcp_f32 v32, v117
v_permlane32_swap_b32 v34, v116
v_mov_b32 v33, v32
v_and_b32 v34, 0xffff, v34
v_lshl_or_b32 v34, v116, 16, v34
v_permlane32_swap_b32 v32, v33
s_waitcnt vmcnt(7)
buffer_store_dwordx4 v[32:35], v118, s[36:39], s60 offen sc1
v_pk_mul_f32 v[120:121], v[100:101], v[84:85]
v_pk_mul_f32 v[122:123], v[102:103], v[84:85]
v_pk_fma_f32 v[98:99], v[100:101], v[86:87], v[122:123]
v_pk_fma_f32 v[96:97], v[102:103], v[86:87], v[120:121] neg_lo:[1,0,0] neg_hi:[1,0,0]
v_cvt_pk_bf16_f32 v57, v98, v99
v_cvt_pk_bf16_f32 v56, v96, v97
v_pk_mul_f32 v[120:121], v[96:97], v[84:85]
v_pk_mul_f32 v[122:123], v[98:99], v[84:85]
v_pk_fma_f32 v[102:103], v[96:97], v[86:87], v[122:123]
v_pk_fma_f32 v[100:101], v[98:99], v[86:87], v[120:121] neg_lo:[1,0,0] neg_hi:[1,0,0]
v_cvt_pk_bf16_f32 v59, v102, v103
v_cvt_pk_bf16_f32 v58, v100, v101
v_pk_mul_f32 v[120:121], v[100:101], v[84:85]
v_pk_mul_f32 v[122:123], v[102:103], v[84:85]
v_pk_fma_f32 v[98:99], v[100:101], v[86:87], v[122:123]
v_pk_fma_f32 v[96:97], v[102:103], v[86:87], v[120:121] neg_lo:[1,0,0] neg_hi:[1,0,0]
v_cvt_pk_bf16_f32 v61, v98, v99
v_cvt_pk_bf16_f32 v60, v96, v97
v_pk_mul_f32 v[120:121], v[96:97], v[84:85]
v_pk_mul_f32 v[122:123], v[98:99], v[84:85]
v_pk_fma_f32 v[102:103], v[96:97], v[86:87], v[122:123]
v_pk_fma_f32 v[100:101], v[98:99], v[86:87], v[120:121] neg_lo:[1,0,0] neg_hi:[1,0,0]
v_cvt_pk_bf16_f32 v63, v102, v103
s_mov_b32 m0, s72
v_cvt_pk_bf16_f32 v62, v100, v101
ds_write_addtid_b32 v57 offset:6592
ds_write_addtid_b32 v56 offset:6336
ds_write_addtid_b32 v59 offset:7120
ds_write_addtid_b32 v58 offset:6864
ds_write_addtid_b32 v61 offset:7648
ds_write_addtid_b32 v60 offset:7392
ds_write_addtid_b32 v63 offset:8176
ds_write_addtid_b32 v62 offset:7920
v_pk_mul_f32 v[120:121], v[100:101], v[84:85]
v_pk_mul_f32 v[122:123], v[102:103], v[84:85]
v_pk_fma_f32 v[98:99], v[100:101], v[86:87], v[122:123]
v_pk_fma_f32 v[96:97], v[102:103], v[86:87], v[120:121] neg_lo:[1,0,0] neg_hi:[1,0,0]
v_cvt_pk_bf16_f32 v57, v98, v99
v_cvt_pk_bf16_f32 v56, v96, v97
v_pk_mul_f32 v[120:121], v[96:97], v[84:85]
v_pk_mul_f32 v[122:123], v[98:99], v[84:85]
v_pk_fma_f32 v[102:103], v[96:97], v[86:87], v[122:123]
v_pk_fma_f32 v[100:101], v[98:99], v[86:87], v[120:121] neg_lo:[1,0,0] neg_hi:[1,0,0]
v_cvt_pk_bf16_f32 v59, v102, v103
v_cvt_pk_bf16_f32 v58, v100, v101
v_pk_mul_f32 v[120:121], v[100:101], v[84:85]
v_pk_mul_f32 v[122:123], v[102:103], v[84:85]
v_pk_fma_f32 v[98:99], v[100:101], v[86:87], v[122:123]
v_pk_fma_f32 v[96:97], v[102:103], v[86:87], v[120:121] neg_lo:[1,0,0] neg_hi:[1,0,0]
v_cvt_pk_bf16_f32 v61, v98, v99
v_cvt_pk_bf16_f32 v60, v96, v97
v_pk_mul_f32 v[120:121], v[96:97], v[84:85]
v_pk_mul_f32 v[122:123], v[98:99], v[84:85]
v_pk_fma_f32 v[102:103], v[96:97], v[86:87], v[122:123]
v_pk_fma_f32 v[100:101], v[98:99], v[86:87], v[120:121] neg_lo:[1,0,0] neg_hi:[1,0,0]
v_cvt_pk_bf16_f32 v63, v102, v103
s_mov_b32 m0, s72
v_cvt_pk_bf16_f32 v62, v100, v101
ds_write_addtid_b32 v57 offset:8704
ds_write_addtid_b32 v56 offset:8448
ds_write_addtid_b32 v59 offset:9232
ds_write_addtid_b32 v58 offset:8976
ds_write_addtid_b32 v61 offset:9760
ds_write_addtid_b32 v60 offset:9504
ds_write_addtid_b32 v63 offset:10288
ds_write_addtid_b32 v62 offset:10032
v_pk_mul_f32 v[120:121], v[100:101], v[84:85]
v_pk_mul_f32 v[122:123], v[102:103], v[84:85]
v_pk_fma_f32 v[98:99], v[100:101], v[86:87], v[122:123]
v_pk_fma_f32 v[96:97], v[102:103], v[86:87], v[120:121] neg_lo:[1,0,0] neg_hi:[1,0,0]
v_cvt_pk_bf16_f32 v57, v98, v99
v_cvt_pk_bf16_f32 v56, v96, v97
v_pk_mul_f32 v[120:121], v[96:97], v[84:85]
v_pk_mul_f32 v[122:123], v[98:99], v[84:85]
v_pk_fma_f32 v[102:103], v[96:97], v[86:87], v[122:123]
v_pk_fma_f32 v[100:101], v[98:99], v[86:87], v[120:121] neg_lo:[1,0,0] neg_hi:[1,0,0]
v_cvt_pk_bf16_f32 v59, v102, v103
v_cvt_pk_bf16_f32 v58, v100, v101
v_pk_mul_f32 v[120:121], v[100:101], v[84:85]
v_pk_mul_f32 v[122:123], v[102:103], v[84:85]
v_pk_fma_f32 v[98:99], v[100:101], v[86:87], v[122:123]
v_pk_fma_f32 v[96:97], v[102:103], v[86:87], v[120:121] neg_lo:[1,0,0] neg_hi:[1,0,0]
v_cvt_pk_bf16_f32 v61, v98, v99
v_cvt_pk_bf16_f32 v60, v96, v97
v_pk_mul_f32 v[120:121], v[96:97], v[84:85]
v_pk_mul_f32 v[122:123], v[98:99], v[84:85]
v_pk_fma_f32 v[102:103], v[96:97], v[86:87], v[122:123]
v_pk_fma_f32 v[100:101], v[98:99], v[86:87], v[120:121] neg_lo:[1,0,0] neg_hi:[1,0,0]
v_cvt_pk_bf16_f32 v63, v102, v103
s_mov_b32 m0, s72
v_cvt_pk_bf16_f32 v62, v100, v101
ds_write_addtid_b32 v57 offset:10816
ds_write_addtid_b32 v56 offset:10560
ds_write_addtid_b32 v59 offset:11344
ds_write_addtid_b32 v58 offset:11088
ds_write_addtid_b32 v61 offset:11872
ds_write_addtid_b32 v60 offset:11616
ds_write_addtid_b32 v63 offset:12400
ds_write_addtid_b32 v62 offset:12144
v_pk_mul_f32 v[120:121], v[100:101], v[84:85]
v_pk_mul_f32 v[122:123], v[102:103], v[84:85]
v_pk_fma_f32 v[98:99], v[100:101], v[86:87], v[122:123]
v_pk_fma_f32 v[96:97], v[102:103], v[86:87], v[120:121] neg_lo:[1,0,0] neg_hi:[1,0,0]
v_cvt_pk_bf16_f32 v57, v98, v99
v_cvt_pk_bf16_f32 v56, v96, v97
v_pk_mul_f32 v[120:121], v[96:97], v[84:85]
v_pk_mul_f32 v[122:123], v[98:99], v[84:85]
v_pk_fma_f32 v[102:103], v[96:97], v[86:87], v[122:123]
v_pk_fma_f32 v[100:101], v[98:99], v[86:87], v[120:121] neg_lo:[1,0,0] neg_hi:[1,0,0]
v_cvt_pk_bf16_f32 v59, v102, v103
v_cvt_pk_bf16_f32 v58, v100, v101
v_pk_mul_f32 v[120:121], v[100:101], v[84:85]
v_pk_mul_f32 v[122:123], v[102:103], v[84:85]
v_pk_fma_f32 v[98:99], v[100:101], v[86:87], v[122:123]
v_pk_fma_f32 v[96:97], v[102:103], v[86:87], v[120:121] neg_lo:[1,0,0] neg_hi:[1,0,0]
v_cvt_pk_bf16_f32 v61, v98, v99
v_cvt_pk_bf16_f32 v60, v96, v97
v_pk_mul_f32 v[120:121], v[96:97], v[84:85]
v_pk_mul_f32 v[122:123], v[98:99], v[84:85]
v_pk_fma_f32 v[102:103], v[96:97], v[86:87], v[122:123]
v_pk_fma_f32 v[100:101], v[98:99], v[86:87], v[120:121] neg_lo:[1,0,0] neg_hi:[1,0,0]
v_cvt_pk_bf16_f32 v63, v102, v103
s_mov_b32 m0, s72
v_cvt_pk_bf16_f32 v62, v100, v101
ds_write_addtid_b32 v57 offset:12928
ds_write_addtid_b32 v56 offset:12672
ds_write_addtid_b32 v59 offset:13456
ds_write_addtid_b32 v58 offset:13200
ds_write_addtid_b32 v61 offset:13984
ds_write_addtid_b32 v60 offset:13728
ds_write_addtid_b32 v63 offset:14512
ds_write_addtid_b32 v62 offset:14256
v_pk_mul_f32 v[120:121], v[100:101], v[84:85]
v_pk_mul_f32 v[122:123], v[102:103], v[84:85]
v_pk_fma_f32 v[98:99], v[100:101], v[86:87], v[122:123]
v_pk_fma_f32 v[96:97], v[102:103], v[86:87], v[120:121] neg_lo:[1,0,0] neg_hi:[1,0,0]
v_cvt_pk_bf16_f32 v57, v98, v99
v_cvt_pk_bf16_f32 v56, v96, v97
v_pk_mul_f32 v[120:121], v[96:97], v[84:85]
v_pk_mul_f32 v[122:123], v[98:99], v[84:85]
v_pk_fma_f32 v[102:103], v[96:97], v[86:87], v[122:123]
v_pk_fma_f32 v[100:101], v[98:99], v[86:87], v[120:121] neg_lo:[1,0,0] neg_hi:[1,0,0]
v_cvt_pk_bf16_f32 v59, v102, v103
v_cvt_pk_bf16_f32 v58, v100, v101
v_pk_mul_f32 v[120:121], v[100:101], v[84:85]
v_pk_mul_f32 v[122:123], v[102:103], v[84:85]
v_pk_fma_f32 v[98:99], v[100:101], v[86:87], v[122:123]
v_pk_fma_f32 v[96:97], v[102:103], v[86:87], v[120:121] neg_lo:[1,0,0] neg_hi:[1,0,0]
v_cvt_pk_bf16_f32 v61, v98, v99
v_cvt_pk_bf16_f32 v60, v96, v97
v_pk_mul_f32 v[120:121], v[96:97], v[84:85]
v_pk_mul_f32 v[122:123], v[98:99], v[84:85]
v_pk_fma_f32 v[102:103], v[96:97], v[86:87], v[122:123]
v_pk_fma_f32 v[100:101], v[98:99], v[86:87], v[120:121] neg_lo:[1,0,0] neg_hi:[1,0,0]
v_cvt_pk_bf16_f32 v63, v102, v103
s_mov_b32 m0, s72
v_cvt_pk_bf16_f32 v62, v100, v101
ds_write_addtid_b32 v57 offset:15040
ds_write_addtid_b32 v56 offset:14784
ds_write_addtid_b32 v59 offset:15568
ds_write_addtid_b32 v58 offset:15312
ds_write_addtid_b32 v61 offset:16096
ds_write_addtid_b32 v60 offset:15840
ds_write_addtid_b32 v63 offset:16624
ds_write_addtid_b32 v62 offset:16368
buffer_load_dword v9, v83, s[44:47], s77 offen
ds_read_b128 v[128:131], v7 offset:0
ds_read_b128 v[132:135], v7 offset:32
ds_read_b128 v[136:139], v7 offset:64
ds_read_b128 v[140:143], v7 offset:96
ds_read_b128 v[144:147], v7 offset:128
ds_read_b128 v[148:151], v7 offset:160
ds_read_b128 v[152:155], v7 offset:192
ds_read_b128 v[156:159], v7 offset:224
ds_read_b128 v[160:163], v7 offset:256
ds_read_b128 v[164:167], v7 offset:288
ds_read_b128 v[168:171], v7 offset:320
ds_read_b128 v[172:175], v7 offset:352
ds_read_b128 v[176:179], v7 offset:384
ds_read_b128 v[180:183], v7 offset:416
ds_read_b128 v[184:187], v7 offset:448
ds_read_b128 v[188:191], v7 offset:480
v_exp_f32 v120, v46
v_fract_f32 v122, v48
v_exp_f32 v121, v47
v_fract_f32 v123, v49
v_cos_f32 v88, v122
v_cos_f32 v89, v123
v_sin_f32 v90, v122
v_sin_f32 v91, v123
v_pk_mul_f32 v[88:89], v[88:89], v[120:121]
v_pk_mul_f32 v[90:91], v[90:91], v[120:121]
v_mul_f32 v120, 0x43800000, v46
v_mul_f32 v122, 0x43800000, v48
v_exp_f32 v120, v120
v_fract_f32 v122, v122
v_mul_f32 v121, 0x43800000, v47
v_mul_f32 v123, 0x43800000, v49
v_exp_f32 v121, v121
v_fract_f32 v123, v123
v_cos_f32 v92, v122
v_cos_f32 v93, v123
v_sin_f32 v94, v122
v_sin_f32 v95, v123
v_pk_mul_f32 v[92:93], v[92:93], v[120:121]
v_pk_mul_f32 v[94:95], v[94:95], v[120:121]
v_add_f32 v45, v45, v45
s_waitcnt vmcnt(8)
v_lshlrev_b32 v96, 16, v42
v_and_b32 v97, s65, v42
s_waitcnt vmcnt(7)
v_lshlrev_b32 v98, 16, v43
v_and_b32 v99, s65, v43
v_pk_mul_f32 v[96:97], v[96:97], v[44:45] op_sel:[0,1] op_sel_hi:[1,1]
v_pk_mul_f32 v[98:99], v[98:99], v[44:45] op_sel:[0,1] op_sel_hi:[1,1] neg_lo:[0,1] neg_hi:[0,1]
v_cvt_pk_bf16_f32 v57, v98, v99
v_cvt_pk_bf16_f32 v56, v96, v97
v_pk_mul_f32 v[120:121], v[96:97], v[92:93]
v_pk_mul_f32 v[122:123], v[98:99], v[92:93]
v_pk_fma_f32 v[106:107], v[96:97], v[94:95], v[122:123] neg_lo:[1,0,0] neg_hi:[1,0,0]
v_pk_fma_f32 v[104:105], v[98:99], v[94:95], v[120:121]
v_cvt_pk_bf16_f32 v59, v106, v107
v_cvt_pk_bf16_f32 v58, v104, v105
v_pk_mul_f32 v[120:121], v[96:97], v[88:89]
v_pk_mul_f32 v[122:123], v[98:99], v[88:89]
v_pk_fma_f32 v[102:103], v[96:97], v[90:91], v[122:123] neg_lo:[1,0,0] neg_hi:[1,0,0]
v_pk_fma_f32 v[100:101], v[98:99], v[90:91], v[120:121]
v_cvt_pk_bf16_f32 v61, v102, v103
v_cvt_pk_bf16_f32 v60, v100, v101
v_pk_mul_f32 v[120:121], v[100:101], v[88:89]
v_pk_mul_f32 v[122:123], v[102:103], v[88:89]
v_pk_fma_f32 v[98:99], v[100:101], v[90:91], v[122:123] neg_lo:[1,0,0] neg_hi:[1,0,0]
v_pk_fma_f32 v[96:97], v[102:103], v[90:91], v[120:121]
v_cvt_pk_bf16_f32 v63, v98, v99
s_mov_b32 m0, s72
v_cvt_pk_bf16_f32 v62, v96, v97
ds_write_addtid_b32 v57 offset:256
ds_write_addtid_b32 v56 offset:0
ds_write_addtid_b32 v59 offset:4480
ds_write_addtid_b32 v58 offset:4224
ds_write_addtid_b32 v61 offset:784
ds_write_addtid_b32 v60 offset:528
ds_write_addtid_b32 v63 offset:1312
ds_write_addtid_b32 v62 offset:1056
s_add_u32 m0, s67, 0
s_add_u32 s78, s66, 0
buffer_load_dwordx4 v3, s[40:43], s78 offen offset:0 lds
buffer_load_dwordx4 v12, s[40:43], s78 offen offset:1024 lds
v_pk_mul_f32 v[120:121], v[96:97], v[92:93]
v_pk_mul_f32 v[122:123], v[98:99], v[92:93]
v_pk_fma_f32 v[114:115], v[96:97], v[94:95], v[122:123] neg_lo:[1,0,0] neg_hi:[1,0,0]
v_pk_fma_f32 v[112:113], v[98:99], v[94:95], v[120:121]
v_cvt_pk_bf16_f32 v57, v114, v115
v_cvt_pk_bf16_f32 v56, v112, v113
v_pk_mul_f32 v[120:121], v[96:97], v[88:89]
v_pk_mul_f32 v[122:123], v[98:99], v[88:89]
v_pk_fma_f32 v[102:103], v[96:97], v[90:91], v[122:123] neg_lo:[1,0,0] neg_hi:[1,0,0]
v_pk_fma_f32 v[100:101], v[98:99], v[90:91], v[120:121]
v_cvt_pk_bf16_f32 v59, v102, v103
v_cvt_pk_bf16_f32 v58, v100, v101
v_pk_mul_f32 v[120:121], v[100:101], v[88:89]
v_pk_mul_f32 v[122:123], v[102:103], v[88:89]
v_pk_fma_f32 v[98:99], v[100:101], v[90:91], v[122:123] neg_lo:[1,0,0] neg_hi:[1,0,0]
v_pk_fma_f32 v[96:97], v[102:103], v[90:91], v[120:121]
v_cvt_pk_bf16_f32 v61, v98, v99
v_cvt_pk_bf16_f32 v60, v96, v97
v_pk_mul_f32 v[120:121], v[96:97], v[92:93]
v_pk_mul_f32 v[122:123], v[98:99], v[92:93]
v_pk_fma_f32 v[110:111], v[96:97], v[94:95], v[122:123] neg_lo:[1,0,0] neg_hi:[1,0,0]
v_pk_fma_f32 v[108:109], v[98:99], v[94:95], v[120:121]
v_cvt_pk_bf16_f32 v63, v110, v111
s_mov_b32 m0, s72
v_cvt_pk_bf16_f32 v62, v108, v109
ds_write_addtid_b32 v57 offset:5008
ds_write_addtid_b32 v56 offset:4752
ds_write_addtid_b32 v59 offset:1840
ds_write_addtid_b32 v58 offset:1584
ds_write_addtid_b32 v61 offset:2368
ds_write_addtid_b32 v60 offset:2112
ds_write_addtid_b32 v63 offset:6592
ds_write_addtid_b32 v62 offset:6336
s_add_u32 m0, s67, 0
s_nop 0
buffer_load_dwordx4 v13, s[40:43], s78 offen offset:2048 lds
buffer_load_dwordx4 v14, s[40:43], s78 offen offset:3072 lds
v_pk_mul_f32 v[120:121], v[96:97], v[88:89]
v_pk_mul_f32 v[122:123], v[98:99], v[88:89]
v_pk_fma_f32 v[102:103], v[96:97], v[90:91], v[122:123] neg_lo:[1,0,0] neg_hi:[1,0,0]
v_pk_fma_f32 v[100:101], v[98:99], v[90:91], v[120:121]
v_cvt_pk_bf16_f32 v57, v102, v103
v_cvt_pk_bf16_f32 v56, v100, v101
v_pk_mul_f32 v[120:121], v[100:101], v[88:89]
v_pk_mul_f32 v[122:123], v[102:103], v[88:89]
v_pk_fma_f32 v[98:99], v[100:101], v[90:91], v[122:123] neg_lo:[1,0,0] neg_hi:[1,0,0]
v_pk_fma_f32 v[96:97], v[102:103], v[90:91], v[120:121]
v_cvt_pk_bf16_f32 v59, v98, v99
v_cvt_pk_bf16_f32 v58, v96, v97
v_pk_mul_f32 v[120:121], v[96:97], v[92:93]
v_pk_mul_f32 v[122:123], v[98:99], v[92:93]
v_pk_fma_f32 v[114:115], v[96:97], v[94:95], v[122:123] neg_lo:[1,0,0] neg_hi:[1,0,0]
v_pk_fma_f32 v[112:113], v[98:99], v[94:95], v[120:121]
v_cvt_pk_bf16_f32 v61, v114, v115
v_cvt_pk_bf16_f32 v60, v112, v113
v_pk_mul_f32 v[120:121], v[96:97], v[88:89]
v_pk_mul_f32 v[122:123], v[98:99], v[88:89]
v_pk_fma_f32 v[102:103], v[96:97], v[90:91], v[122:123] neg_lo:[1,0,0] neg_hi:[1,0,0]
v_pk_fma_f32 v[100:101], v[98:99], v[90:91], v[120:121]
v_cvt_pk_bf16_f32 v63, v102, v103
s_mov_b32 m0, s72
v_cvt_pk_bf16_f32 v62, v100, v101
ds_write_addtid_b32 v57 offset:2896
ds_write_addtid_b32 v56 offset:2640
ds_write_addtid_b32 v59 offset:3424
ds_write_addtid_b32 v58 offset:3168
ds_write_addtid_b32 v61 offset:7120
ds_write_addtid_b32 v60 offset:6864
ds_write_addtid_b32 v63 offset:3952
ds_write_addtid_b32 v62 offset:3696
s_add_u32 m0, s67, 4096
s_add_u32 s78, s66, 114688
buffer_load_dwordx4 v3, s[40:43], s78 offen offset:0 lds
buffer_load_dwordx4 v12, s[40:43], s78 offen offset:1024 lds
v_pk_mul_f32 v[120:121], v[104:105], v[92:93]
v_pk_mul_f32 v[122:123], v[106:107], v[92:93]
v_pk_fma_f32 v[98:99], v[104:105], v[94:95], v[122:123] neg_lo:[1,0,0] neg_hi:[1,0,0]
v_pk_fma_f32 v[96:97], v[106:107], v[94:95], v[120:121]
v_cvt_pk_bf16_f32 v57, v98, v99
v_cvt_pk_bf16_f32 v56, v96, v97
v_pk_mul_f32 v[120:121], v[108:109], v[92:93]
v_pk_mul_f32 v[122:123], v[110:111], v[92:93]
v_pk_fma_f32 v[102:103], v[108:109], v[94:95], v[122:123] neg_lo:[1,0,0] neg_hi:[1,0,0]
v_pk_fma_f32 v[100:101], v[110:111], v[94:95], v[120:121]
v_cvt_pk_bf16_f32 v59, v102, v103
v_cvt_pk_bf16_f32 v58, v100, v101
v_pk_mul_f32 v[120:121], v[96:97], v[92:93]
v_pk_mul_f32 v[122:123], v[98:99], v[92:93]
v_pk_fma_f32 v[106:107], v[96:97], v[94:95], v[122:123] neg_lo:[1,0,0] neg_hi:[1,0,0]
v_pk_fma_f32 v[104:105], v[98:99], v[94:95], v[120:121]
v_cvt_pk_bf16_f32 v61, v106, v107
v_cvt_pk_bf16_f32 v60, v104, v105
v_pk_mul_f32 v[120:121], v[100:101], v[92:93]
v_pk_mul_f32 v[122:123], v[102:103], v[92:93]
v_pk_fma_f32 v[110:111], v[100:101], v[94:95], v[122:123] neg_lo:[1,0,0] neg_hi:[1,0,0]
v_pk_fma_f32 v[108:109], v[102:103], v[94:95], v[120:121]
v_cvt_pk_bf16_f32 v63, v110, v111
s_mov_b32 m0, s72
v_cvt_pk_bf16_f32 v62, v108, v109
ds_write_addtid_b32 v57 offset:5536
ds_write_addtid_b32 v56 offset:5280
ds_write_addtid_b32 v59 offset:7648
ds_write_addtid_b32 v58 offset:7392
ds_write_addtid_b32 v61 offset:6064
ds_write_addtid_b32 v60 offset:5808
ds_write_addtid_b32 v63 offset:8176
ds_write_addtid_b32 v62 offset:7920
s_add_u32 m0, s67, 4096
s_nop 0
buffer_load_dwordx4 v13, s[40:43], s78 offen offset:2048 lds
buffer_load_dwordx4 v14, s[40:43], s78 offen offset:3072 lds
v_pk_mul_f32 v[120:121], v[104:105], v[92:93]
v_pk_mul_f32 v[122:123], v[106:107], v[92:93]
v_pk_fma_f32 v[98:99], v[104:105], v[94:95], v[122:123] neg_lo:[1,0,0] neg_hi:[1,0,0]
v_pk_fma_f32 v[96:97], v[106:107], v[94:95], v[120:121]
v_cvt_pk_bf16_f32 v57, v98, v99
v_cvt_pk_bf16_f32 v56, v96, v97
v_pk_mul_f32 v[120:121], v[96:97], v[92:93]
v_pk_mul_f32 v[122:123], v[98:99], v[92:93]
v_pk_fma_f32 v[102:103], v[96:97], v[94:95], v[122:123] neg_lo:[1,0,0] neg_hi:[1,0,0]
v_pk_fma_f32 v[100:101], v[98:99], v[94:95], v[120:121]
v_cvt_pk_bf16_f32 v59, v102, v103
v_cvt_pk_bf16_f32 v58, v100, v101
v_pk_mul_f32 v[120:121], v[100:101], v[92:93]
v_pk_mul_f32 v[122:123], v[102:103], v[92:93]
v_pk_fma_f32 v[98:99], v[100:101], v[94:95], v[122:123] neg_lo:[1,0,0] neg_hi:[1,0,0]
v_pk_fma_f32 v[96:97], v[102:103], v[94:95], v[120:121]
v_cvt_pk_bf16_f32 v61, v98, v99
v_cvt_pk_bf16_f32 v60, v96, v97
v_pk_mul_f32 v[120:121], v[96:97], v[92:93]
v_pk_mul_f32 v[122:123], v[98:99], v[92:93]
v_pk_fma_f32 v[102:103], v[96:97], v[94:95], v[122:123] neg_lo:[1,0,0] neg_hi:[1,0,0]
v_pk_fma_f32 v[100:101], v[98:99], v[94:95], v[120:121]
v_cvt_pk_bf16_f32 v63, v102, v103
s_mov_b32 m0, s72
v_cvt_pk_bf16_f32 v62, v100, v101
ds_write_addtid_b32 v57 offset:8704
ds_write_addtid_b32 v56 offset:8448
ds_write_addtid_b32 v59 offset:9232
ds_write_addtid_b32 v58 offset:8976
ds_write_addtid_b32 v61 offset:9760
ds_write_addtid_b32 v60 offset:9504
ds_write_addtid_b32 v63 offset:10288
ds_write_addtid_b32 v62 offset:10032
s_add_u32 m0, s67, 8192
s_add_u32 s78, s66, 229376
buffer_load_dwordx4 v3, s[40:43], s78 offen offset:0 lds
buffer_load_dwordx4 v12, s[40:43], s78 offen offset:1024 lds
v_pk_mul_f32 v[120:121], v[100:101], v[92:93]
v_pk_mul_f32 v[122:123], v[102:103], v[92:93]
v_pk_fma_f32 v[98:99], v[100:101], v[94:95], v[122:123] neg_lo:[1,0,0] neg_hi:[1,0,0]
v_pk_fma_f32 v[96:97], v[102:103], v[94:95], v[120:121]
v_cvt_pk_bf16_f32 v57, v98, v99
s_mov_b32 m0, s72
v_cvt_pk_bf16_f32 v56, v96, v97
ds_write_addtid_b32 v57 offset:12928
ds_write_addtid_b32 v56 offset:12672
s_add_u32 m0, s67, 8192
s_nop 0
buffer_load_dwordx4 v13, s[40:43], s78 offen offset:2048 lds
buffer_load_dwordx4 v14, s[40:43], s78 offen offset:3072 lds
ds_read_b128 v[192:195], v7 offset:0
ds_read_b128 v[196:199], v7 offset:32
ds_read_b128 v[200:203], v7 offset:64
ds_read_b128 v[204:207], v7 offset:96
ds_read_b128 v[208:211], v7 offset:128
ds_read_b128 v[212:215], v7 offset:160
ds_read_b128 v[216:219], v7 offset:192
ds_read_b128 v[220:223], v7 offset:224
ds_read_b128 v[224:227], v7 offset:256
ds_read_b128 v[228:231], v7 offset:288
ds_read_b128 v[232:235], v7 offset:320
ds_read_b128 v[236:239], v7 offset:352
ds_read_b128 v[240:243], v7 offset:384
ds_read_b128 v[244:247], v7 offset:416
ds_read_b128 v[248:251], v7 offset:448
ds_read_b128 v[252:255], v7 offset:480
s_waitcnt lgkmcnt(15)
v_mfma_f32_32x32x16_bf16 v[96:111], v[192:195], v[128:131], 0
s_mul_i32 s74, s57, 16640
s_add_u32 s74, s74, 65536
v_and_b32 v50, 1, v1
s_waitcnt lgkmcnt(14)
v_mfma_f32_32x32x16_bf16 v[96:111], v[196:199], v[132:135], v[96:111]
s_waitcnt vmcnt(10)
ds_read_b64_tr_b16 a[0:1], v4 offset:0
ds_read_b64_tr_b16 a[2:3], v4 offset:512
v_mul_u32_u24 v50, 4160, v50
v_and_b32 v51, 14, v1
v_lshlrev_b32 v51, 1, v51
s_waitcnt lgkmcnt(15)
v_mfma_f32_32x32x16_bf16 v[96:111], v[200:203], v[136:139], v[96:111]
ds_read_b64_tr_b16 a[4:5], v5 offset:0
ds_read_b64_tr_b16 a[6:7], v5 offset:512
v_sub_u32 v50, v50, v51
v_lshrrev_b32 v51, 4, v1
v_lshl_add_u32 v50, v51, 4, v50
s_waitcnt lgkmcnt(15)
v_mfma_f32_32x32x16_bf16 v[96:111], v[204:207], v[140:143], v[96:111]
s_waitcnt vmcnt(8)
ds_read_b64_tr_b16 a[8:9], v4 offset:2048
ds_read_b64_tr_b16 a[10:11], v4 offset:2560
v_mfma_f32_32x32x16_bf16 v[96:111], v[208:211], v[144:147], v[96:111]
s_and_b32 s76, s34, 1
ds_read_b64_tr_b16 a[12:13], v5 offset:2048
s_lshl_b32 s77, s76, 8
s_sub_u32 s61, s75, s77
s_add_u32 s61, s61, 284
v_add_u32 v84, s61, v50
s_waitcnt lgkmcnt(15)
v_mfma_f32_32x32x16_bf16 v[96:111], v[212:215], v[148:151], v[96:111]
ds_read_b64_tr_b16 a[14:15], v5 offset:2560
s_add_u32 m0, s67, 0
v_add_u32 v85, 1024, v84
v_add_u32 v86, 2048, v84
v_add_u32 v87, 3072, v84
v_mfma_f32_32x32x16_bf16 v[96:111], v[216:219], v[152:155], v[96:111]
s_add_u32 s78, s66, 344064
s_waitcnt lgkmcnt(4)
buffer_load_dwordx4 v3, s[40:43], s78 offen offset:0 lds
v_and_b32 v50, 15, v1
v_lshlrev_b32 v50, 5, v50
v_lshl_add_u32 v50, v51, 4, v50
v_mfma_f32_32x32x16_bf16 v[96:111], v[220:223], v[156:159], v[96:111]
buffer_load_dwordx4 v12, s[40:43], s78 offen offset:1024 lds
v_mfma_f32_32x32x16_bf16 v[96:111], v[224:227], v[160:163], v[96:111]
s_waitcnt vmcnt(8)
ds_read_b64_tr_b16 a[16:17], v4 offset:4096
s_lshr_b32 s3, s34, 1
s_mul_i32 s61, s3, 4608
ds_read_b64_tr_b16 a[18:19], v4 offset:4608
s_sub_u32 s61, s61, s77
s_add_u32 s61, s61, 149280
v_add_u32 v88, s61, v50
v_mfma_f32_32x32x16_bf16 v[96:111], v[228:231], v[164:167], v[96:111]
ds_read_b64_tr_b16 a[20:21], v5 offset:4096
ds_read_b64_tr_b16 a[22:23], v5 offset:4608
v_lshlrev_b32 v90, 2, v0
v_add_u32 v89, 149504, v90
v_lshrrev_b32 v50, 1, v1
v_mfma_f32_32x32x16_bf16 v[96:111], v[232:235], v[168:171], v[96:111]
s_add_u32 m0, s67, 0
v_mul_u32_u24 v50, 4160, v50
v_and_b32 v51, 1, v1
v_lshl_add_u32 v50, v51, 4, v50
v_mfma_f32_32x32x16_bf16 v[96:111], v[236:239], v[172:175], v[96:111]
s_waitcnt lgkmcnt(4)
buffer_load_dwordx4 v13, s[40:43], s78 offen offset:2048 lds
buffer_load_dwordx4 v14, s[40:43], s78 offen offset:3072 lds
v_add_u32 v91, s75, v50
v_mov_b32 v56, 0
v_mfma_f32_32x32x16_bf16 v[96:111], v[240:243], v[176:179], v[96:111]
s_waitcnt vmcnt(8)
ds_read_b64_tr_b16 a[24:25], v4 offset:6144
ds_read_b64_tr_b16 a[26:27], v4 offset:6656
v_mov_b32 v57, 0
v_mov_b32 v58, 0
v_mov_b32 v59, 0
v_mfma_f32_32x32x16_bf16 v[96:111], v[244:247], v[180:183], v[96:111]
ds_read_b64_tr_b16 a[28:29], v5 offset:6144
v_lshrrev_b32 v50, 5, v1
v_xor_b32 v50, v50, v1
v_mfma_f32_32x32x16_bf16 v[96:111], v[248:251], v[184:187], v[96:111]
ds_read_b64_tr_b16 a[30:31], v5 offset:6656
s_add_u32 m0, s67, 4096
s_mul_i32 s76, s76, 16640
v_mfma_f32_32x32x16_bf16 v[96:111], v[252:255], v[188:191], v[96:111]
s_mul_i32 s3, s3, 8320
s_add_u32 s78, s66, 458752
s_add_u32 s76, s76, s3
s_waitcnt lgkmcnt(4)
buffer_load_dwordx4 v3, s[40:43], s78 offen offset:0 lds
s_add_u32 s76, s76, 41728
buffer_load_dwordx4 v12, s[40:43], s78 offen offset:1024 lds
v_lshl_add_u32 v92, v50, 4, s76
v_xor_b32 v8, 4, v6
s_nop 2
v_add_f32 v96, v96, v82
ds_write2_b32 v6, v96, v97 offset0:0 offset1:32
ds_write2_b32 v6, v98, v99 offset0:64 offset1:96
ds_write2st64_b32 v8, v100, v101 offset0:4 offset1:5
ds_write2st64_b32 v6, v102, v104 offset0:8 offset1:16
ds_write2st64_b32 v8, v103, v105 offset0:12 offset1:20
ds_write_b32 v6, v106 offset:6144
ds_write_b32 v8, v107 offset:7168
ds_write_b32 v6, v108 offset:7296
s_add_u32 s60, s74, 0
buffer_load_dwordx4 v[16:19], v11, s[36:39], s60 offen sc1
s_mov_b32 s60, 4096
buffer_load_dwordx4 v[32:35], v11, s[36:39], s60 offen sc1
s_add_u32 s60, s74, 4096
buffer_load_dwordx4 v[20:23], v11, s[36:39], s60 offen sc1
s_mov_b32 s60, 8192
buffer_load_dwordx4 v[36:39], v11, s[36:39], s60 offen sc1
s_add_u32 s60, s74, 8192
buffer_load_dwordx4 v[24:27], v11, s[36:39], s60 offen sc1
s_mov_b32 s60, 12288
buffer_load_dwordx4 v[40:43], v11, s[36:39], s60 offen sc1
s_add_u32 s60, s74, 12288
buffer_load_dwordx4 v[28:31], v11, s[36:39], s60 offen sc1
s_mov_b32 s60, 16384
buffer_load_dwordx4 v[44:47], v11, s[36:39], s60 offen sc1
s_waitcnt lgkmcnt(0)
s_barrier
ds_read2st64_b32 v[224:225], v80 offset0:0 offset1:66
ds_read2st64_b32 v[222:223], v79 offset0:0 offset1:66
ds_read2st64_b32 v[220:221], v78 offset0:0 offset1:66
ds_read2st64_b32 v[218:219], v77 offset0:0 offset1:66
ds_read2st64_b32 v[216:217], v76 offset0:0 offset1:66
ds_read2st64_b32 v[214:215], v75 offset0:0 offset1:66
ds_read2st64_b32 v[212:213], v74 offset0:0 offset1:66
ds_read2st64_b32 v[210:211], v73 offset0:0 offset1:66
ds_read2st64_b32 v[208:209], v72 offset0:0 offset1:66
ds_read2st64_b32 v[206:207], v71 offset0:0 offset1:66
ds_read2st64_b32 v[204:205], v70 offset0:0 offset1:66
ds_read2st64_b32 v[202:203], v69 offset0:0 offset1:66
ds_read2st64_b32 v[200:201], v68 offset0:0 offset1:66
ds_read2st64_b32 v[198:199], v67 offset0:0 offset1:66
ds_read2st64_b32 v[196:197], v66 offset0:0 offset1:66
ds_read2st64_b32 v[194:195], v65 offset0:0 offset1:66
ds_read2st64_b32 v[192:193], v64 offset0:0 offset1:66
s_mov_b64 exec, 0xf
ds_write_b128 v91, v[56:59] offset:4096
s_mov_b64 exec, -1
s_waitcnt lgkmcnt(15)
v_add_f32 v80, v224, v225
v_add_f32 v79, v222, v223
v_cvt_pk_bf16_f32 v132, v80, v79
v_add_f32 v78, v220, v221
s_waitcnt lgkmcnt(14)
v_add_f32 v77, v218, v219
v_cvt_pk_bf16_f32 v133, v78, v77
s_waitcnt lgkmcnt(13)
v_add_f32 v76, v216, v217
s_waitcnt lgkmcnt(12)
v_add_f32 v75, v214, v215
v_cvt_pk_bf16_f32 v134, v76, v75
s_waitcnt lgkmcnt(11)
v_add_f32 v74, v212, v213
s_waitcnt lgkmcnt(10)
v_add_f32 v73, v210, v211
v_cvt_pk_bf16_f32 v135, v74, v73
v_cvt_pk_bf16_f32 v128, v79, v78
v_cvt_pk_bf16_f32 v129, v77, v76
v_cvt_pk_bf16_f32 v130, v75, v74
s_waitcnt lgkmcnt(9)
v_add_f32 v72, v208, v209
v_cvt_pk_bf16_f32 v131, v73, v72
ds_write_b128 v81, v[132:135] offset:4160
ds_write_b128 v81, v[128:131] offset:0
s_waitcnt lgkmcnt(10)
v_add_f32 v71, v206, v207
v_cvt_pk_bf16_f32 v140, v72, v71
s_waitcnt lgkmcnt(9)
v_add_f32 v70, v204, v205
s_waitcnt lgkmcnt(8)
v_add_f32 v69, v202, v203
v_cvt_pk_bf16_f32 v141, v70, v69
s_waitcnt lgkmcnt(7)
v_add_f32 v68, v200, v201
s_waitcnt lgkmcnt(6)
v_add_f32 v67, v198, v199
v_cvt_pk_bf16_f32 v142, v68, v67
s_waitcnt lgkmcnt(5)
v_add_f32 v66, v196, v197
s_waitcnt lgkmcnt(4)
v_add_f32 v65, v194, v195
v_cvt_pk_bf16_f32 v143, v66, v65
v_cvt_pk_bf16_f32 v136, v71, v70
v_cvt_pk_bf16_f32 v137, v69, v68
v_cvt_pk_bf16_f32 v138, v67, v66
s_waitcnt lgkmcnt(3)
v_add_f32 v64, v192, v193
v_cndmask_b32 v64, v64, v56, s[80:81]
v_cvt_pk_bf16_f32 v139, v65, v64
ds_write_b128 v81, v[140:143] offset:4176
ds_write_b128 v81, v[136:139] offset:16
s_mov_b32 s68, 0
L_h1:
s_waitcnt vmcnt(0)
v_bitop3_b32 v48, v18, v19, s35 bitop3:0x7e
v_bitop3_b32 v49, v22, v23, s35 bitop3:0x7e
v_bitop3_b32 v50, v26, v27, s35 bitop3:0x7e
v_bitop3_b32 v51, v30, v31, s35 bitop3:0x7e
v_bitop3_b32 v56, v35, v39, s35 bitop3:0x7e
v_bitop3_b32 v57, v43, v47, s35 bitop3:0x7e
v_or3_b32 v48, v48, v49, v50
v_or3_b32 v51, v51, v56, v57
v_or_b32 v48, v48, v51
v_cmp_ne_u32 vcc, 0, v48
s_cbranch_vccnz L_h1re
L_h1ok:
v_lshlrev_b32 v64, 16, v16
v_lshlrev_b32 v65, 16, v17
v_and_b32 v66, s65, v16
v_and_b32 v67, s65, v17
v_and_b32 v35, s65, v34
v_lshlrev_b32 v34, 16, v34
v_pk_add_f32 v[64:65], v[64:65], v[34:35] neg_lo:[0,1] neg_hi:[0,1]
v_pk_add_f32 v[66:67], v[66:67], v[34:35] neg_lo:[0,1] neg_hi:[0,1]
v_pk_mul_f32 v[64:65], v[64:65], v[32:33]
v_pk_mul_f32 v[66:67], v[66:67], v[32:33]
v_cvt_pk_bf16_f32 v64, v64, v65
v_cvt_pk_bf16_f32 v66, v66, v67
v_lshlrev_b32 v68, 16, v20
v_lshlrev_b32 v69, 16, v21
v_and_b32 v70, s65, v20
v_and_b32 v71, s65, v21
v_and_b32 v39, s65, v38
v_lshlrev_b32 v38, 16, v38
v_pk_add_f32 v[68:69], v[68:69], v[38:39] neg_lo:[0,1] neg_hi:[0,1]
v_pk_add_f32 v[70:71], v[70:71], v[38:39] neg_lo:[0,1] neg_hi:[0,1]
v_pk_mul_f32 v[68:69], v[68:69], v[36:37]
v_pk_mul_f32 v[70:71], v[70:71], v[36:37]
v_cvt_pk_bf16_f32 v68, v68, v69
v_cvt_pk_bf16_f32 v70, v70, v71
v_lshlrev_b32 v72, 16, v24
v_lshlrev_b32 v73, 16, v25
v_and_b32 v74, s65, v24
v_and_b32 v75, s65, v25
v_and_b32 v43, s65, v42
v_lshlrev_b32 v42, 16, v42
v_pk_add_f32 v[72:73], v[72:73], v[42:43] neg_lo:[0,1] neg_hi:[0,1]
v_pk_add_f32 v[74:75], v[74:75], v[42:43] neg_lo:[0,1] neg_hi:[0,1]
v_pk_mul_f32 v[72:73], v[72:73], v[40:41]
v_pk_mul_f32 v[74:75], v[74:75], v[40:41]
v_cvt_pk_bf16_f32 v72, v72, v73
v_cvt_pk_bf16_f32 v74, v74, v75
v_lshlrev_b32 v76, 16, v28
v_lshlrev_b32 v77, 16, v29
v_and_b32 v78, s65, v28
v_and_b32 v79, s65, v29
v_and_b32 v47, s65, v46
v_lshlrev_b32 v46, 16, v46
v_pk_add_f32 v[76:77], v[76:77], v[46:47] neg_lo:[0,1] neg_hi:[0,1]
v_pk_add_f32 v[78:79], v[78:79], v[46:47] neg_lo:[0,1] neg_hi:[0,1]
v_pk_mul_f32 v[76:77], v[76:77], v[44:45]
v_pk_mul_f32 v[78:79], v[78:79], v[44:45]
v_cvt_pk_bf16_f32 v76, v76, v77
v_cvt_pk_bf16_f32 v78, v78, v79
ds_write2st64_b32 v89, v64, v66 offset0:0 offset1:18
ds_write2st64_b32 v89, v68, v70 offset0:4 offset1:22
ds_write2st64_b32 v89, v72, v74 offset0:8 offset1:26
ds_write2st64_b32 v89, v76, v78 offset0:12 offset1:30
s_waitcnt lgkmcnt(0)
s_barrier
ds_read2_b32 v[128:129], v87 offset0:176 offset1:177
ds_read2_b32 v[130:131], v87 offset0:178 offset1:179
ds_read_b128 v[192:195], v88 offset:192
ds_read2_b32 v[132:133], v87 offset0:48 offset1:49
ds_read2_b32 v[134:135], v87 offset0:50 offset1:51
ds_read_b128 v[196:199], v88 offset:704
ds_read2_b32 v[136:137], v86 offset0:176 offset1:177
ds_read2_b32 v[138:139], v86 offset0:178 offset1:179
ds_read_b128 v[200:203], v88 offset:1216
ds_read2_b32 v[140:141], v86 offset0:48 offset1:49
ds_read2_b32 v[142:143], v86 offset0:50 offset1:51
ds_read_b128 v[204:207], v88 offset:1728
ds_read2_b32 v[144:145], v85 offset0:176 offset1:177
ds_read2_b32 v[146:147], v85 offset0:178 offset1:179
ds_read_b128 v[208:211], v88 offset:2240
ds_read2_b32 v[148:149], v85 offset0:48 offset1:49
ds_read2_b32 v[150:151], v85 offset0:50 offset1:51
ds_read_b128 v[212:215], v88 offset:2752
ds_read2_b32 v[152:153], v84 offset0:176 offset1:177
ds_read2_b32 v[154:155], v84 offset0:178 offset1:179
ds_read_b128 v[216:219], v88 offset:3264
ds_read2_b32 v[156:157], v84 offset0:48 offset1:49
ds_read2_b32 v[158:159], v84 offset0:50 offset1:51
ds_read_b128 v[220:223], v88 offset:3776
s_mov_b32 s76, 0x05040100
s_mov_b32 s77, 0x07060302
s_waitcnt lgkmcnt(15)
v_mfma_f32_16x16x32_bf16 v[96:99], v[128:131], v[192:195], 0
v_mfma_f32_16x16x32_bf16 v[100:103], v[128:131], v[196:199], 0
v_mfma_f32_16x16x32_bf16 v[100:103], v[132:135], v[192:195], v[100:103]
v_perm_b32 v18, v17, v16, s76
v_mfma_f32_16x16x32_bf16 v[104:107], v[132:135], v[196:199], 0
v_mfma_f32_16x16x32_bf16 v[104:107], v[128:131], v[200:203], v[104:107]
v_perm_b32 v19, v17, v16, s77
v_mfma_f32_16x16x32_bf16 v[104:107], v[136:139], v[192:195], v[104:107]
v_mfma_f32_16x16x32_bf16 v[108:111], v[132:135], v[200:203], 0
ds_read2_b32 v[160:161], v87 offset0:160 offset1:161
v_mfma_f32_16x16x32_bf16 v[108:111], v[136:139], v[196:199], v[108:111]
ds_write2st64_b32 v90, v18, v19 offset0:32 offset1:48
v_mfma_f32_16x16x32_bf16 v[112:115], v[136:139], v[200:203], 0
ds_read2_b32 v[162:163], v87 offset0:162 offset1:163
s_add_u32 m0, s67, 4096
s_waitcnt lgkmcnt(15)
v_mfma_f32_16x16x32_bf16 v[108:111], v[128:131], v[204:207], v[108:111]
ds_read_b128 v[224:227], v88 offset:128
buffer_load_dwordx4 v13, s[40:43], s78 offen offset:2048 lds
v_perm_b32 v22, v21, v20, s76
v_mfma_f32_16x16x32_bf16 v[108:111], v[140:143], v[192:195], v[108:111]
ds_read2_b32 v[164:165], v87 offset0:32 offset1:33
ds_read_b64_tr_b16 a[32:33], v4 offset:8192
v_mfma_f32_16x16x32_bf16 v[112:115], v[132:135], v[204:207], v[112:115]
ds_read2_b32 v[166:167], v87 offset0:34 offset1:35
ds_read_b64_tr_b16 a[34:35], v4 offset:8704
v_perm_b32 v23, v21, v20, s77
v_mfma_f32_16x16x32_bf16 v[112:115], v[140:143], v[196:199], v[112:115]
ds_read_b128 v[228:231], v88 offset:640
v_mfma_f32_16x16x32_bf16 v[116:119], v[136:139], v[204:207], 0
ds_read_b64_tr_b16 a[36:37], v5 offset:8192
ds_read2_b32 v[168:169], v86 offset0:160 offset1:161
v_mfma_f32_16x16x32_bf16 v[116:119], v[140:143], v[200:203], v[116:119]
ds_write2st64_b32 v90, v22, v23 offset0:36 offset1:52
buffer_load_dwordx4 v14, s[40:43], s78 offen offset:3072 lds
ds_read2_b32 v[170:171], v86 offset0:162 offset1:163
v_mfma_f32_16x16x32_bf16 v[120:123], v[140:143], v[204:207], 0
ds_read_b64_tr_b16 a[38:39], v5 offset:8704
ds_read_b128 v[232:235], v88 offset:1152
s_waitcnt lgkmcnt(15)
v_mfma_f32_16x16x32_bf16 v[112:115], v[128:131], v[208:211], v[112:115]
ds_read2_b32 v[172:173], v86 offset0:32 offset1:33
s_add_u32 m0, s67, 8192
v_perm_b32 v26, v25, v24, s76
v_mfma_f32_16x16x32_bf16 v[112:115], v[144:147], v[192:195], v[112:115]
ds_read2_b32 v[174:175], v86 offset0:34 offset1:35
v_mfma_f32_16x16x32_bf16 v[116:119], v[132:135], v[208:211], v[116:119]
s_add_u32 s78, s66, 573440
ds_read_b128 v[236:239], v88 offset:1664
v_perm_b32 v27, v25, v24, s77
v_mfma_f32_16x16x32_bf16 v[116:119], v[144:147], v[196:199], v[116:119]
s_waitcnt lgkmcnt(4)
buffer_load_dwordx4 v3, s[40:43], s78 offen offset:0 lds
v_mfma_f32_16x16x32_bf16 v[120:123], v[136:139], v[208:211], v[120:123]
ds_read2_b32 v[176:177], v85 offset0:160 offset1:161
ds_read_b64_tr_b16 a[40:41], v4 offset:10240
v_mfma_f32_16x16x32_bf16 v[120:123], v[144:147], v[200:203], v[120:123]
ds_write2st64_b32 v90, v26, v27 offset0:40 offset1:56
ds_read2_b32 v[178:179], v85 offset0:162 offset1:163
ds_read_b64_tr_b16 a[42:43], v4 offset:10752
v_mfma_f32_16x16x32_bf16 v[124:127], v[140:143], v[208:211], 0
ds_read_b128 v[240:243], v88 offset:2176
ds_read_b64_tr_b16 a[44:45], v5 offset:10240
v_mfma_f32_16x16x32_bf16 v[124:127], v[144:147], v[204:207], v[124:127]
ds_read2_b32 v[180:181], v85 offset0:32 offset1:33
v_perm_b32 v30, v29, v28, s76
v_mfma_f32_16x16x32_bf16 v[116:119], v[128:131], v[212:215], v[116:119]
buffer_load_dwordx4 v12, s[40:43], s78 offen offset:1024 lds
ds_read2_b32 v[182:183], v85 offset0:34 offset1:35
v_mfma_f32_16x16x32_bf16 v[116:119], v[148:151], v[192:195], v[116:119]
ds_read_b64_tr_b16 a[46:47], v5 offset:10752
ds_read_b128 v[244:247], v88 offset:2688
v_perm_b32 v31, v29, v28, s77
v_mfma_f32_16x16x32_bf16 v[120:123], v[132:135], v[212:215], v[120:123]
ds_read2_b32 v[184:185], v84 offset0:160 offset1:161
v_mfma_f32_16x16x32_bf16 v[120:123], v[148:151], v[196:199], v[120:123]
ds_read2_b32 v[186:187], v84 offset0:162 offset1:163
s_add_u32 m0, s67, 8192
v_mfma_f32_16x16x32_bf16 v[124:127], v[136:139], v[212:215], v[124:127]
ds_write2st64_b32 v90, v30, v31 offset0:44 offset1:60
ds_read_b128 v[248:251], v88 offset:3200
v_mfma_f32_16x16x32_bf16 v[124:127], v[148:151], v[200:203], v[124:127]
s_waitcnt lgkmcnt(5)
buffer_load_dwordx4 v13, s[40:43], s78 offen offset:2048 lds
ds_read2_b32 v[188:189], v84 offset0:32 offset1:33
v_mfma_f32_16x16x32_bf16 v[120:123], v[128:131], v[216:219], v[120:123]
ds_read_b64_tr_b16 a[48:49], v4 offset:0
ds_read2_b32 v[190:191], v84 offset0:34 offset1:35
v_mfma_f32_16x16x32_bf16 v[120:123], v[152:155], v[192:195], v[120:123]
ds_read_b64_tr_b16 a[50:51], v4 offset:512
ds_read_b128 v[252:255], v88 offset:3712
v_mfma_f32_16x16x32_bf16 v[124:127], v[132:135], v[216:219], v[124:127]
ds_read_b64_tr_b16 a[52:53], v5 offset:0
v_mfma_f32_16x16x32_bf16 v[124:127], v[152:155], v[196:199], v[124:127]
buffer_load_dwordx4 v14, s[40:43], s78 offen offset:3072 lds
v_mfma_f32_16x16x32_bf16 v[124:127], v[128:131], v[220:223], v[124:127]
ds_read_b64_tr_b16 a[54:55], v5 offset:512
v_mfma_f32_16x16x32_bf16 v[124:127], v[156:159], v[192:195], v[124:127]
s_add_u32 m0, s67, 0
s_waitcnt lgkmcnt(2)
v_mfma_f32_16x16x32_bf16 v[96:99], v[160:163], v[224:227], v[96:99]
ds_read2_b32 v[128:129], v87 offset0:144 offset1:145
v_mfma_f32_16x16x32_bf16 v[100:103], v[160:163], v[228:231], v[100:103]
s_add_u32 s78, s66, 688128
v_mfma_f32_16x16x32_bf16 v[100:103], v[164:167], v[224:227], v[100:103]
ds_read2_b32 v[130:131], v87 offset0:146 offset1:147
s_waitcnt lgkmcnt(2)
buffer_load_dwordx4 v3, s[40:43], s78 offen offset:0 lds
v_mfma_f32_16x16x32_bf16 v[104:107], v[164:167], v[228:231], v[104:107]
ds_read_b128 v[192:195], v88 offset:64
v_mfma_f32_16x16x32_bf16 v[104:107], v[160:163], v[232:235], v[104:107]
ds_read_b64_tr_b16 a[56:57], v4 offset:2048
ds_read2_b32 v[132:133], v87 offset0:16 offset1:17
v_mfma_f32_16x16x32_bf16 v[104:107], v[168:171], v[224:227], v[104:107]
ds_read_b64_tr_b16 a[58:59], v4 offset:2560
v_mfma_f32_16x16x32_bf16 v[108:111], v[164:167], v[232:235], v[108:111]
ds_read2_b32 v[134:135], v87 offset0:18 offset1:19
ds_read_b64_tr_b16 a[60:61], v5 offset:2048
v_mfma_f32_16x16x32_bf16 v[108:111], v[168:171], v[228:231], v[108:111]
ds_read_b128 v[196:199], v88 offset:576
buffer_load_dwordx4 v12, s[40:43], s78 offen offset:1024 lds
v_mfma_f32_16x16x32_bf16 v[112:115], v[168:171], v[232:235], v[112:115]
ds_read2_b32 v[136:137], v86 offset0:144 offset1:145
ds_read_b64_tr_b16 a[62:63], v5 offset:2560
v_mfma_f32_16x16x32_bf16 v[108:111], v[160:163], v[236:239], v[108:111]
ds_read2_b32 v[138:139], v86 offset0:146 offset1:147
v_mfma_f32_16x16x32_bf16 v[108:111], v[172:175], v[224:227], v[108:111]
ds_read_b128 v[200:203], v88 offset:1088
v_mfma_f32_16x16x32_bf16 v[112:115], v[164:167], v[236:239], v[112:115]
s_add_u32 m0, s67, 0
v_mfma_f32_16x16x32_bf16 v[112:115], v[172:175], v[228:231], v[112:115]
ds_read2_b32 v[140:141], v86 offset0:16 offset1:17
s_waitcnt lgkmcnt(3)
buffer_load_dwordx4 v13, s[40:43], s78 offen offset:2048 lds
v_mfma_f32_16x16x32_bf16 v[116:119], v[168:171], v[236:239], v[116:119]
ds_read2_b32 v[142:143], v86 offset0:18 offset1:19
ds_read_b64_tr_b16 a[64:65], v4 offset:4096
v_mfma_f32_16x16x32_bf16 v[116:119], v[172:175], v[232:235], v[116:119]
ds_read_b128 v[204:207], v88 offset:1600
v_mfma_f32_16x16x32_bf16 v[120:123], v[172:175], v[236:239], v[120:123]
ds_read_b64_tr_b16 a[66:67], v4 offset:4608
v_mfma_f32_16x16x32_bf16 v[112:115], v[160:163], v[240:243], v[112:115]
ds_read2_b32 v[144:145], v85 offset0:144 offset1:145
ds_read_b64_tr_b16 a[68:69], v5 offset:4096
v_mfma_f32_16x16x32_bf16 v[112:115], v[176:179], v[224:227], v[112:115]
ds_read2_b32 v[146:147], v85 offset0:146 offset1:147
buffer_load_dwordx4 v14, s[40:43], s78 offen offset:3072 lds
v_mfma_f32_16x16x32_bf16 v[116:119], v[164:167], v[240:243], v[116:119]
ds_read_b128 v[208:211], v88 offset:2112
ds_read_b64_tr_b16 a[70:71], v5 offset:4608
v_mfma_f32_16x16x32_bf16 v[116:119], v[176:179], v[228:231], v[116:119]
ds_read2_b32 v[148:149], v85 offset0:16 offset1:17
s_add_u32 m0, s67, 4096
v_mfma_f32_16x16x32_bf16 v[120:123], v[168:171], v[240:243], v[120:123]
ds_read2_b32 v[150:151], v85 offset0:18 offset1:19
v_mfma_f32_16x16x32_bf16 v[120:123], v[176:179], v[232:235], v[120:123]
s_add_u32 s78, s66, 802816
v_mfma_f32_16x16x32_bf16 v[124:127], v[172:175], v[240:243], v[124:127]
ds_read_b128 v[212:215], v88 offset:2624
s_waitcnt lgkmcnt(3)
buffer_load_dwordx4 v3, s[40:43], s78 offen offset:0 lds
v_mfma_f32_16x16x32_bf16 v[124:127], v[176:179], v[236:239], v[124:127]
ds_read2_b32 v[152:153], v84 offset0:144 offset1:145
s_waitcnt vmcnt(9)
ds_read_b64_tr_b16 a[72:73], v4 offset:6144
v_mfma_f32_16x16x32_bf16 v[116:119], v[160:163], v[244:247], v[116:119]
ds_read2_b32 v[154:155], v84 offset0:146 offset1:147
ds_read_b64_tr_b16 a[74:75], v4 offset:6656
v_mfma_f32_16x16x32_bf16 v[116:119], v[180:183], v[224:227], v[116:119]
ds_read_b128 v[216:219], v88 offset:3136
v_mfma_f32_16x16x32_bf16 v[120:123], v[164:167], v[244:247], v[120:123]
ds_read_b64_tr_b16 a[76:77], v5 offset:6144
v_mfma_f32_16x16x32_bf16 v[120:123], v[180:183], v[228:231], v[120:123]
ds_read2_b32 v[156:157], v84 offset0:16 offset1:17
buffer_load_dwordx4 v12, s[40:43], s78 offen offset:1024 lds
v_mfma_f32_16x16x32_bf16 v[124:127], v[168:171], v[244:247], v[124:127]
ds_read_b64_tr_b16 a[78:79], v5 offset:6656
ds_read2_b32 v[158:159], v84 offset0:18 offset1:19
v_or_b32 v50, s2, v0
v_mfma_f32_16x16x32_bf16 v[124:127], v[180:183], v[232:235], v[124:127]
ds_read_b128 v[220:223], v88 offset:3648
v_mfma_f32_16x16x32_bf16 v[120:123], v[160:163], v[248:251], v[120:123]
s_add_u32 m0, s67, 4096
v_min_u32 v50, 1, v50
v_mfma_f32_16x16x32_bf16 v[120:123], v[184:187], v[224:227], v[120:123]
s_waitcnt lgkmcnt(2)
buffer_load_dwordx4 v13, s[40:43], s78 offen offset:2048 lds
v_mfma_f32_16x16x32_bf16 v[124:127], v[164:167], v[248:251], v[124:127]
s_waitcnt vmcnt(9)
ds_read_b64_tr_b16 a[80:81], v4 offset:8192
v_lshlrev_b32 v50, 25, v50
v_mfma_f32_16x16x32_bf16 v[124:127], v[184:187], v[228:231], v[124:127]
ds_read_b64_tr_b16 a[82:83], v4 offset:8704
v_mfma_f32_16x16x32_bf16 v[124:127], v[160:163], v[252:255], v[124:127]
buffer_store_dword v2, v50, s[36:39], 0 offen sc1
v_mfma_f32_16x16x32_bf16 v[124:127], v[188:191], v[224:227], v[124:127]
ds_read_b64_tr_b16 a[84:85], v5 offset:8192
s_waitcnt lgkmcnt(3)
v_mfma_f32_16x16x32_bf16 v[96:99], v[128:131], v[192:195], v[96:99]
s_barrier
v_mfma_f32_16x16x32_bf16 v[100:103], v[128:131], v[196:199], v[100:103]
ds_read2_b32 v[160:161], v87 offset0:128 offset1:129
buffer_load_dwordx4 v14, s[40:43], s78 offen offset:3072 lds
v_mfma_f32_16x16x32_bf16 v[100:103], v[132:135], v[192:195], v[100:103]
ds_read2_b32 v[162:163], v87 offset0:130 offset1:131
ds_read_b64_tr_b16 a[86:87], v5 offset:8704
v_mfma_f32_16x16x32_bf16 v[104:107], v[132:135], v[196:199], v[104:107]
ds_read_b128 v[224:227], v88 offset:0
s_add_u32 m0, s67, 8192
v_mfma_f32_16x16x32_bf16 v[104:107], v[128:131], v[200:203], v[104:107]
s_add_u32 s78, s66, 917504
ds_read2_b32 v[164:165], v87 offset0:0 offset1:1
v_mfma_f32_16x16x32_bf16 v[104:107], v[136:139], v[192:195], v[104:107]
s_waitcnt lgkmcnt(2)
buffer_load_dwordx4 v3, s[40:43], s78 offen offset:0 lds
v_mfma_f32_16x16x32_bf16 v[108:111], v[132:135], v[200:203], v[108:111]
ds_read2_b32 v[166:167], v87 offset0:2 offset1:3
v_mfma_f32_16x16x32_bf16 v[108:111], v[136:139], v[196:199], v[108:111]
s_waitcnt vmcnt(10)
ds_read_b64_tr_b16 a[88:89], v4 offset:10240
ds_read_b128 v[228:231], v88 offset:512
v_mfma_f32_16x16x32_bf16 v[112:115], v[136:139], v[200:203], v[112:115]
ds_read_b64_tr_b16 a[90:91], v4 offset:10752
ds_read2_b32 v[168:169], v86 offset0:128 offset1:129
v_mfma_f32_16x16x32_bf16 v[108:111], v[128:131], v[204:207], v[108:111]
ds_read_b64_tr_b16 a[92:93], v5 offset:10240
ds_read2_b32 v[170:171], v86 offset0:130 offset1:131
v_mfma_f32_16x16x32_bf16 v[108:111], v[140:143], v[192:195], v[108:111]
buffer_load_dwordx4 v12, s[40:43], s78 offen offset:1024 lds
v_mfma_f32_16x16x32_bf16 v[112:115], v[132:135], v[204:207], v[112:115]
ds_read_b128 v[232:235], v88 offset:1024
v_mfma_f32_16x16x32_bf16 v[112:115], v[140:143], v[196:199], v[112:115]
ds_read_b64_tr_b16 a[94:95], v5 offset:10752
ds_read2_b32 v[172:173], v86 offset0:0 offset1:1
v_mfma_f32_16x16x32_bf16 v[116:119], v[136:139], v[204:207], v[116:119]
ds_read2_b32 v[174:175], v86 offset0:2 offset1:3
v_mfma_f32_16x16x32_bf16 v[116:119], v[140:143], v[200:203], v[116:119]
s_add_u32 m0, s67, 8192
ds_read_b128 v[236:239], v88 offset:1536
v_mfma_f32_16x16x32_bf16 v[120:123], v[140:143], v[204:207], v[120:123]
s_waitcnt lgkmcnt(3)
buffer_load_dwordx4 v13, s[40:43], s78 offen offset:2048 lds
v_mfma_f32_16x16x32_bf16 v[112:115], v[128:131], v[208:211], v[112:115]
ds_read2_b32 v[176:177], v85 offset0:128 offset1:129
s_waitcnt vmcnt(10)
ds_read_b64_tr_b16 a[96:97], v4 offset:0
v_mfma_f32_16x16x32_bf16 v[112:115], v[144:147], v[192:195], v[112:115]
ds_read2_b32 v[178:179], v85 offset0:130 offset1:131
v_mfma_f32_16x16x32_bf16 v[116:119], v[132:135], v[208:211], v[116:119]
ds_read_b64_tr_b16 a[98:99], v4 offset:512
ds_read_b128 v[240:243], v88 offset:2048
v_mfma_f32_16x16x32_bf16 v[116:119], v[144:147], v[196:199], v[116:119]
ds_read_b64_tr_b16 a[100:101], v5 offset:0
ds_read2_b32 v[180:181], v85 offset0:0 offset1:1
v_mfma_f32_16x16x32_bf16 v[120:123], v[136:139], v[208:211], v[120:123]
buffer_load_dwordx4 v14, s[40:43], s78 offen offset:3072 lds
v_mfma_f32_16x16x32_bf16 v[120:123], v[144:147], v[200:203], v[120:123]
ds_read2_b32 v[182:183], v85 offset0:2 offset1:3
ds_read_b64_tr_b16 a[102:103], v5 offset:512
v_mfma_f32_16x16x32_bf16 v[124:127], v[140:143], v[208:211], v[124:127]
ds_read_b128 v[244:247], v88 offset:2560
v_mfma_f32_16x16x32_bf16 v[124:127], v[144:147], v[204:207], v[124:127]
s_add_u32 m0, s67, 0
ds_read2_b32 v[184:185], v84 offset0:128 offset1:129
v_mfma_f32_16x16x32_bf16 v[116:119], v[128:131], v[212:215], v[116:119]
s_add_u32 s78, s66, 1032192
ds_read2_b32 v[186:187], v84 offset0:130 offset1:131
v_mfma_f32_16x16x32_bf16 v[116:119], v[148:151], v[192:195], v[116:119]
s_waitcnt lgkmcnt(3)
buffer_load_dwordx4 v3, s[40:43], s78 offen offset:0 lds
v_mfma_f32_16x16x32_bf16 v[120:123], v[132:135], v[212:215], v[120:123]
ds_read_b128 v[248:251], v88 offset:3072
s_waitcnt vmcnt(10)
ds_read_b64_tr_b16 a[104:105], v4 offset:2048
v_and_b32 v50, 1, v1
v_mfma_f32_16x16x32_bf16 v[120:123], v[148:151], v[196:199], v[120:123]
ds_read2_b32 v[188:189], v84 offset0:0 offset1:1
ds_read_b64_tr_b16 a[106:107], v4 offset:2560
v_lshrrev_b32 v51, 2, v1
v_mfma_f32_16x16x32_bf16 v[124:127], v[136:139], v[212:215], v[124:127]
ds_read2_b32 v[190:191], v84 offset0:2 offset1:3
v_bfe_u32 v57, v1, 1, 1
v_mfma_f32_16x16x32_bf16 v[124:127], v[148:151], v[200:203], v[124:127]
ds_read_b64_tr_b16 a[108:109], v5 offset:2048
ds_read_b128 v[252:255], v88 offset:3584
v_lshlrev_b32 v56, 5, v51
v_mfma_f32_16x16x32_bf16 v[120:123], v[128:131], v[216:219], v[120:123]
buffer_load_dwordx4 v12, s[40:43], s78 offen offset:1024 lds
v_lshl_add_u32 v56, v50, 4, v56
v_mfma_f32_16x16x32_bf16 v[120:123], v[152:155], v[192:195], v[120:123]
ds_read_b64_tr_b16 a[110:111], v5 offset:2560
v_lshl_add_u32 v56, v57, 12, v56
v_mfma_f32_16x16x32_bf16 v[124:127], v[132:135], v[216:219], v[124:127]
s_lshl_b32 s61, s34, 9
v_mfma_f32_16x16x32_bf16 v[124:127], v[152:155], v[196:199], v[124:127]
s_add_u32 m0, s67, 0
v_add_u32 v56, s61, v56
v_mfma_f32_16x16x32_bf16 v[124:127], v[128:131], v[220:223], v[124:127]
ds_read_b128 v[16:19], v56 offset:8192
v_mfma_f32_16x16x32_bf16 v[124:127], v[156:159], v[192:195], v[124:127]
s_waitcnt lgkmcnt(1)
buffer_load_dwordx4 v13, s[40:43], s78 offen offset:2048 lds
ds_read_b128 v[20:23], v56 offset:10240
v_mfma_f32_16x16x32_bf16 v[96:99], v[160:163], v[224:227], v[96:99]
s_waitcnt vmcnt(10)
ds_read_b64_tr_b16 a[112:113], v4 offset:4096
v_xor_b32 v56, v51, v50
v_mfma_f32_16x16x32_bf16 v[100:103], v[160:163], v[228:231], v[100:103]
ds_read_b64_tr_b16 a[114:115], v4 offset:4608
v_lshlrev_b32 v56, 4, v56
v_mfma_f32_16x16x32_bf16 v[100:103], v[164:167], v[224:227], v[100:103]
ds_read_b64_tr_b16 a[116:117], v5 offset:4096
v_lshl_add_u32 v56, v50, 9, v56
v_mfma_f32_16x16x32_bf16 v[104:107], v[160:163], v[232:235], v[104:107]
buffer_load_dwordx4 v14, s[40:43], s78 offen offset:3072 lds
v_mul_u32_u24 v58, 8320, v57
v_mfma_f32_16x16x32_bf16 v[104:107], v[164:167], v[228:231], v[104:107]
ds_write_b128 v92, v[96:99] offset:0
v_mfma_f32_16x16x32_bf16 v[104:107], v[168:171], v[224:227], v[104:107]
ds_read_b64_tr_b16 a[118:119], v5 offset:4608
s_lshl_b32 s61, s34, 10
v_mfma_f32_16x16x32_bf16 v[108:111], v[160:163], v[236:239], v[108:111]
s_add_u32 m0, s67, 4096
v_mfma_f32_16x16x32_bf16 v[108:111], v[164:167], v[232:235], v[108:111]
s_add_u32 s61, s61, 41728
s_add_u32 s78, s66, 1146880
v_add3_u32 v93, v56, v58, s61
v_mfma_f32_16x16x32_bf16 v[108:111], v[168:171], v[228:231], v[108:111]
ds_write_b128 v92, v[100:103] offset:1024
v_lshrrev_b32 v51, 2, v0
v_mfma_f32_16x16x32_bf16 v[108:111], v[172:175], v[224:227], v[108:111]
s_waitcnt lgkmcnt(1)
buffer_load_dwordx4 v3, s[40:43], s78 offen offset:0 lds
v_mul_u32_u24 v51, 14336, v51
v_mfma_f32_16x16x32_bf16 v[112:115], v[160:163], v[240:243], v[112:115]
s_waitcnt vmcnt(9)
ds_read_b64_tr_b16 a[120:121], v4 offset:6144
v_and_b32 v50, 3, v1
v_mfma_f32_16x16x32_bf16 v[112:115], v[164:167], v[236:239], v[112:115]
ds_read_b64_tr_b16 a[122:123], v4 offset:6656
v_mfma_f32_16x16x32_bf16 v[112:115], v[168:171], v[232:235], v[112:115]
ds_read_b64_tr_b16 a[124:125], v5 offset:6144
ds_write_b128 v92, v[104:107] offset:2048
v_lshl_add_u32 v95, v50, 4, v51
v_mfma_f32_16x16x32_bf16 v[112:115], v[172:175], v[228:231], v[112:115]
buffer_load_dwordx4 v12, s[40:43], s78 offen offset:1024 lds
v_mfma_f32_16x16x32_bf16 v[112:115], v[176:179], v[224:227], v[112:115]
s_lshl_b32 s76, s57, 6
v_mfma_f32_16x16x32_bf16 v[116:119], v[160:163], v[244:247], v[116:119]
ds_read_b64_tr_b16 a[126:127], v5 offset:6656
s_add_u32 s76, s76, 4194304
v_mfma_f32_16x16x32_bf16 v[116:119], v[164:167], v[240:243], v[116:119]
s_add_u32 s77, s76, 917504
ds_write_b128 v92, v[108:111] offset:3072
v_lshlrev_b32 v24, 16, v16
v_mfma_f32_16x16x32_bf16 v[116:119], v[168:171], v[236:239], v[116:119]
s_add_u32 m0, s67, 4096
v_mfma_f32_16x16x32_bf16 v[116:119], v[172:175], v[232:235], v[116:119]
s_waitcnt lgkmcnt(1)
buffer_load_dwordx4 v13, s[40:43], s78 offen offset:2048 lds
v_and_b32 v25, s65, v16
v_mfma_f32_16x16x32_bf16 v[116:119], v[176:179], v[228:231], v[116:119]
s_waitcnt vmcnt(9)
ds_read_b64_tr_b16 a[128:129], v4 offset:8192
v_lshlrev_b32 v26, 16, v17
v_mfma_f32_16x16x32_bf16 v[116:119], v[180:183], v[224:227], v[116:119]
ds_write_b128 v92, v[112:115] offset:4096
v_and_b32 v27, s65, v17
v_mfma_f32_16x16x32_bf16 v[120:123], v[160:163], v[248:251], v[120:123]
ds_read_b64_tr_b16 a[130:131], v4 offset:8704
v_lshlrev_b32 v28, 16, v18
v_mfma_f32_16x16x32_bf16 v[120:123], v[164:167], v[244:247], v[120:123]
ds_read_b64_tr_b16 a[132:133], v5 offset:8192
v_and_b32 v29, s65, v18
v_mfma_f32_16x16x32_bf16 v[120:123], v[168:171], v[240:243], v[120:123]
buffer_load_dwordx4 v14, s[40:43], s78 offen offset:3072 lds
v_mfma_f32_16x16x32_bf16 v[120:123], v[172:175], v[236:239], v[120:123]
ds_read_b64_tr_b16 a[134:135], v5 offset:8704
ds_write_b128 v92, v[116:119] offset:5120
v_lshlrev_b32 v30, 16, v19
v_mfma_f32_16x16x32_bf16 v[120:123], v[176:179], v[232:235], v[120:123]
s_add_u32 m0, s67, 8192
v_and_b32 v31, s65, v19
v_mfma_f32_16x16x32_bf16 v[120:123], v[180:183], v[228:231], v[120:123]
s_add_u32 s78, s66, 1261568
v_lshlrev_b32 v32, 16, v20
v_mfma_f32_16x16x32_bf16 v[120:123], v[184:187], v[224:227], v[120:123]
s_waitcnt lgkmcnt(1)
buffer_load_dwordx4 v3, s[40:43], s78 offen offset:0 lds
v_and_b32 v33, s65, v20
v_mfma_f32_16x16x32_bf16 v[124:127], v[160:163], v[252:255], v[124:127]
s_waitcnt vmcnt(9)
ds_read_b64_tr_b16 a[136:137], v4 offset:10240
v_lshlrev_b32 v34, 16, v21
v_mfma_f32_16x16x32_bf16 v[124:127], v[164:167], v[248:251], v[124:127]
v_mfma_f32_16x16x32_bf16 v[124:127], v[168:171], v[244:247], v[124:127]
ds_read_b64_tr_b16 a[138:139], v4 offset:10752
v_and_b32 v35, s65, v21
v_mfma_f32_16x16x32_bf16 v[124:127], v[172:175], v[240:243], v[124:127]
ds_write_b128 v92, v[120:123] offset:6144
v_lshlrev_b32 v36, 16, v22
v_mfma_f32_16x16x32_bf16 v[124:127], v[176:179], v[236:239], v[124:127]
ds_read_b64_tr_b16 a[140:141], v5 offset:10240
v_and_b32 v37, s65, v22
v_mfma_f32_16x16x32_bf16 v[124:127], v[180:183], v[232:235], v[124:127]
buffer_load_dwordx4 v12, s[40:43], s78 offen offset:1024 lds
v_lshlrev_b32 v38, 16, v23
v_mfma_f32_16x16x32_bf16 v[124:127], v[184:187], v[228:231], v[124:127]
ds_read_b64_tr_b16 a[142:143], v5 offset:10752
v_and_b32 v39, s65, v23
v_mfma_f32_16x16x32_bf16 v[124:127], v[188:191], v[224:227], v[124:127]
s_nop 7
ds_write_b128 v92, v[124:127] offset:7168
s_waitcnt lgkmcnt(0)
s_barrier
ds_read_b128 v[128:131], v93 offset:0
ds_read_b128 v[132:135], v93 offset:256
ds_read_b128 v[136:139], v93 offset:16640
ds_read_b128 v[140:143], v93 offset:16896
ds_read_b128 v[144:147], v93 offset:4096
ds_read_b128 v[148:151], v93 offset:4352
ds_read_b128 v[152:155], v93 offset:20736
ds_read_b128 v[156:159], v93 offset:20992
s_waitcnt lgkmcnt(7)
v_pk_add_f32 v[128:129], v[128:129], v[24:25]
v_pk_add_f32 v[130:131], v[130:131], v[26:27]
s_waitcnt lgkmcnt(6)
v_pk_add_f32 v[132:133], v[132:133], v[28:29]
v_pk_add_f32 v[134:135], v[134:135], v[30:31]
s_waitcnt lgkmcnt(5)
v_pk_add_f32 v[128:129], v[128:129], v[136:137]
v_pk_add_f32 v[130:131], v[130:131], v[138:139]
s_waitcnt lgkmcnt(4)
v_pk_add_f32 v[132:133], v[132:133], v[140:141]
v_pk_add_f32 v[134:135], v[134:135], v[142:143]
v_cvt_pk_bf16_f32 v16, v128, v129
v_cvt_pk_bf16_f32 v17, v130, v131
v_cvt_pk_bf16_f32 v18, v132, v133
v_cvt_pk_bf16_f32 v19, v134, v135
buffer_store_dwordx4 v[16:19], v95, s[36:39], s76 offen sc1
s_waitcnt lgkmcnt(3)
v_pk_add_f32 v[144:145], v[144:145], v[32:33]
v_pk_add_f32 v[146:147], v[146:147], v[34:35]
s_waitcnt lgkmcnt(2)
v_pk_add_f32 v[148:149], v[148:149], v[36:37]
v_pk_add_f32 v[150:151], v[150:151], v[38:39]
s_waitcnt lgkmcnt(1)
v_pk_add_f32 v[144:145], v[144:145], v[152:153]
v_pk_add_f32 v[146:147], v[146:147], v[154:155]
s_waitcnt lgkmcnt(0)
v_pk_add_f32 v[148:149], v[148:149], v[156:157]
v_pk_add_f32 v[150:151], v[150:151], v[158:159]
v_cvt_pk_bf16_f32 v20, v144, v145
v_cvt_pk_bf16_f32 v21, v146, v147
v_cvt_pk_bf16_f32 v22, v148, v149
v_cvt_pk_bf16_f32 v23, v150, v151
buffer_store_dwordx4 v[20:23], v95, s[36:39], s77 offen sc1
s_barrier
v_and_b32 v50, 31, v1
v_cmp_eq_u32 vcc, 0, v50
v_cmp_eq_u32 s[80:81], 20, v50
v_mov_b32 v56, s62
s_or_b64 vcc, vcc, s[80:81]
v_mov_b32 v57, s62
v_lshl_add_u32 v50, v50, 1, s66
v_cndmask_b32 v64, 0, v56, vcc
v_cndmask_b32 v65, 0, v56, vcc
v_cndmask_b32 v66, 0, v56, vcc
v_cndmask_b32 v67, 0, v56, vcc
global_load_ushort v60, v50, s[22:23]
global_load_ushort v61, v50, s[22:23] offset:64
v_mfma_f32_16x16x32_bf16 v[68:71], v[64:67], a[0:3], 0
s_mul_i32 s88, s34, 14464
v_mfma_f32_16x16x32_bf16 v[72:75], v[64:67], a[4:7], 0
s_waitcnt vmcnt(12)
ds_read_b64_tr_b16 a[144:145], v4 offset:0
s_lshl_b32 s89, s58, 2
ds_read_b64_tr_b16 a[146:147], v4 offset:512
v_mfma_f32_16x16x32_bf16 v[68:71], v[64:67], a[8:11], v[68:71]
s_add_u32 s89, s89, s34
s_mul_i32 s89, s89, 14336
ds_read_b64_tr_b16 a[148:149], v5 offset:0
v_mfma_f32_16x16x32_bf16 v[72:75], v[64:67], a[12:15], v[72:75]
s_add_u32 s89, s89, 4194304
ds_read_b64_tr_b16 a[150:151], v5 offset:512
v_mul_u32_u24 v51, 586, v1
v_mfma_f32_16x16x32_bf16 v[68:71], v[64:67], a[16:19], v[68:71]
s_movk_i32 s61, 0x60
s_add_u32 m0, s67, 8192
v_add_u32 v50, 0, v51
v_lshrrev_b32 v50, 11, v50
v_mfma_f32_16x16x32_bf16 v[72:75], v[64:67], a[20:23], v[72:75]
buffer_load_dwordx4 v13, s[40:43], s78 offen offset:2048 lds
v_bitop3_b32 v134, v10, v50, s61 bitop3:0x78
v_mfma_f32_16x16x32_bf16 v[68:71], v[64:67], a[24:27], v[68:71]
buffer_load_dwordx4 v14, s[40:43], s78 offen offset:3072 lds
v_add_u32 v50, 37504, v51
v_lshrrev_b32 v50, 11, v50
v_mfma_f32_16x16x32_bf16 v[72:75], v[64:67], a[28:31], v[72:75]
s_waitcnt vmcnt(12)
ds_read_b64_tr_b16 a[152:153], v4 offset:2048
v_bitop3_b32 v135, v10, v50, s61 bitop3:0x78
v_add_u32 v50, 75008, v51
v_mfma_f32_16x16x32_bf16 v[68:71], v[64:67], a[32:35], v[68:71]
ds_read_b64_tr_b16 a[154:155], v4 offset:2560
v_lshrrev_b32 v50, 11, v50
v_mfma_f32_16x16x32_bf16 v[72:75], v[64:67], a[36:39], v[72:75]
ds_read_b64_tr_b16 a[156:157], v5 offset:2048
v_bitop3_b32 v136, v10, v50, s61 bitop3:0x78
v_add_u32 v50, 112512, v51
v_mfma_f32_16x16x32_bf16 v[68:71], v[64:67], a[40:43], v[68:71]
ds_read_b64_tr_b16 a[158:159], v5 offset:2560
v_lshrrev_b32 v50, 11, v50
v_bitop3_b32 v137, v10, v50, s61 bitop3:0x78
v_mfma_f32_16x16x32_bf16 v[72:75], v[64:67], a[44:47], v[72:75]
s_add_u32 m0, s67, 0
v_add_u32 v50, 150016, v51
v_mfma_f32_16x16x32_bf16 v[68:71], v[64:67], a[48:51], v[68:71]
s_add_u32 s78, s66, 1376256
v_lshrrev_b32 v50, 11, v50
v_bitop3_b32 v138, v10, v50, s61 bitop3:0x78
v_mfma_f32_16x16x32_bf16 v[72:75], v[64:67], a[52:55], v[72:75]
s_waitcnt lgkmcnt(4)
buffer_load_dwordx4 v3, s[40:43], s78 offen offset:0 lds
v_add_u32 v50, 187520, v51
v_mfma_f32_16x16x32_bf16 v[68:71], v[64:67], a[56:59], v[68:71]
buffer_load_dwordx4 v12, s[40:43], s78 offen offset:1024 lds
v_lshrrev_b32 v50, 11, v50
v_bitop3_b32 v139, v10, v50, s61 bitop3:0x78
v_mfma_f32_16x16x32_bf16 v[72:75], v[64:67], a[60:63], v[72:75]
s_waitcnt vmcnt(12)
ds_read_b64_tr_b16 a[160:161], v4 offset:4096
v_add_u32 v50, 225024, v51
v_lshrrev_b32 v50, 11, v50
v_mfma_f32_16x16x32_bf16 v[68:71], v[64:67], a[64:67], v[68:71]
ds_read_b64_tr_b16 a[162:163], v4 offset:4608
v_bitop3_b32 v140, v10, v50, s61 bitop3:0x78
v_mfma_f32_16x16x32_bf16 v[72:75], v[64:67], a[68:71], v[72:75]
ds_read_b64_tr_b16 a[164:165], v5 offset:4096
v_mfma_f32_16x16x32_bf16 v[68:71], v[64:67], a[72:75], v[68:71]
s_mul_i32 s83, s34, 7168
ds_read_b64_tr_b16 a[166:167], v5 offset:4608
s_mul_i32 s82, s59, 229376
v_mfma_f32_16x16x32_bf16 v[72:75], v[64:67], a[76:79], v[72:75]
s_add_u32 s82, s82, s83
s_add_u32 m0, s67, 0
s_add_u32 s83, s83, 75008
v_mfma_f32_16x16x32_bf16 v[68:71], v[64:67], a[80:83], v[68:71]
s_waitcnt lgkmcnt(4)
buffer_load_dwordx4 v13, s[40:43], s78 offen offset:2048 lds
s_mul_i32 s60, s34, 224
v_mfma_f32_16x16x32_bf16 v[72:75], v[64:67], a[84:87], v[72:75]
s_lshl_b32 s90, s59, 5
buffer_load_dwordx4 v14, s[40:43], s78 offen offset:3072 lds
s_add_u32 s10, s90, 32
v_mfma_f32_16x16x32_bf16 v[68:71], v[64:67], a[88:91], v[68:71]
s_sub_u32 s61, s10, 224
s_waitcnt vmcnt(12)
ds_read_b64_tr_b16 a[168:169], v4 offset:6144
s_min_u32 s10, s10, s61
v_mfma_f32_16x16x32_bf16 v[72:75], v[64:67], a[92:95], v[72:75]
ds_read_b64_tr_b16 a[170:171], v4 offset:6656
s_add_u32 s10, s10, s60
v_mfma_f32_16x16x32_bf16 v[68:71], v[64:67], a[96:99], v[68:71]
s_add_u32 s11, s90, 64
ds_read_b64_tr_b16 a[172:173], v5 offset:6144
s_sub_u32 s61, s11, 224
v_mfma_f32_16x16x32_bf16 v[72:75], v[64:67], a[100:103], v[72:75]
ds_read_b64_tr_b16 a[174:175], v5 offset:6656
s_min_u32 s11, s11, s61
v_mfma_f32_16x16x32_bf16 v[68:71], v[64:67], a[104:107], v[68:71]
s_add_u32 s11, s11, s60
s_add_u32 m0, s67, 4096
s_add_u32 s12, s90, 96
v_mfma_f32_16x16x32_bf16 v[72:75], v[64:67], a[108:111], v[72:75]
s_sub_u32 s61, s12, 224
s_add_u32 s78, s66, 1490944
s_min_u32 s12, s12, s61
v_mfma_f32_16x16x32_bf16 v[68:71], v[64:67], a[112:115], v[68:71]
s_waitcnt lgkmcnt(4)
buffer_load_dwordx4 v3, s[40:43], s78 offen offset:0 lds
s_add_u32 s12, s12, s60
v_mfma_f32_16x16x32_bf16 v[72:75], v[64:67], a[116:119], v[72:75]
s_add_u32 s13, s90, 128
buffer_load_dwordx4 v12, s[40:43], s78 offen offset:1024 lds
s_sub_u32 s61, s13, 224
v_mfma_f32_16x16x32_bf16 v[68:71], v[64:67], a[120:123], v[68:71]
s_waitcnt vmcnt(12)
ds_read_b64_tr_b16 a[176:177], v4 offset:8192
s_min_u32 s13, s13, s61
s_add_u32 s13, s13, s60
v_mfma_f32_16x16x32_bf16 v[72:75], v[64:67], a[124:127], v[72:75]
ds_read_b64_tr_b16 a[178:179], v4 offset:8704
s_add_u32 s14, s90, 160
v_mfma_f32_16x16x32_bf16 v[68:71], v[64:67], a[128:131], v[68:71]
s_sub_u32 s61, s14, 224
ds_read_b64_tr_b16 a[180:181], v5 offset:8192
s_min_u32 s14, s14, s61
v_mfma_f32_16x16x32_bf16 v[72:75], v[64:67], a[132:135], v[72:75]
ds_read_b64_tr_b16 a[182:183], v5 offset:8704
s_add_u32 s14, s14, s60
s_add_u32 s15, s90, 192
v_mfma_f32_16x16x32_bf16 v[68:71], v[64:67], a[136:139], v[68:71]
s_add_u32 m0, s67, 4096
s_sub_u32 s61, s15, 224
v_mfma_f32_16x16x32_bf16 v[72:75], v[64:67], a[140:143], v[72:75]
s_waitcnt lgkmcnt(4)
buffer_load_dwordx4 v13, s[40:43], s78 offen offset:2048 lds
s_min_u32 s15, s15, s61
s_add_u32 s15, s15, s60
buffer_load_dwordx4 v14, s[40:43], s78 offen offset:3072 lds
s_add_u32 s90, s90, s60
s_add_u32 s78, s82, 0
s_add_u32 m0, s83, 57344
s_nop 0
buffer_load_dwordx4 v134, s[44:47], s78 offen offset:0 lds
buffer_load_dwordx4 v135, s[44:47], s78 offen offset:1024 lds
buffer_load_dwordx4 v136, s[44:47], s78 offen offset:2048 lds
buffer_load_dwordx4 v137, s[44:47], s78 offen offset:3072 lds
s_add_u32 s78, s82, 4096
s_add_u32 m0, s83, 61440
s_nop 0
buffer_load_dwordx4 v138, s[44:47], s78 offen offset:0 lds
buffer_load_dwordx4 v139, s[44:47], s78 offen offset:1024 lds
buffer_load_dwordx4 v140, s[44:47], s78 offen offset:2048 lds
s_waitcnt vmcnt(19)
s_add_u32 m0, s88, 0
s_add_u32 s79, s89, 0
buffer_load_dwordx4 v10, s[36:39], s79 offen offset:0 sc1 lds
buffer_load_dwordx4 v10, s[36:39], s79 offen offset:1024 sc1 lds
buffer_load_dwordx4 v10, s[36:39], s79 offen offset:2048 sc1 lds
buffer_load_dwordx4 v10, s[36:39], s79 offen offset:3072 sc1 lds
s_waitcnt vmcnt(19)
ds_read_b64_tr_b16 a[184:185], v4 offset:10240
ds_read_b64_tr_b16 a[186:187], v4 offset:10752
ds_read_b64_tr_b16 a[188:189], v5 offset:10240
ds_read_b64_tr_b16 a[190:191], v5 offset:10752
s_waitcnt vmcnt(17)
ds_read_b64_tr_b16 a[192:193], v4 offset:0
ds_read_b64_tr_b16 a[194:195], v4 offset:512
ds_read_b64_tr_b16 a[196:197], v5 offset:0
ds_read_b64_tr_b16 a[198:199], v5 offset:512
s_waitcnt vmcnt(15)
ds_read_b64_tr_b16 a[200:201], v4 offset:2048
ds_read_b64_tr_b16 a[202:203], v4 offset:2560
ds_read_b64_tr_b16 a[204:205], v5 offset:2048
ds_read_b64_tr_b16 a[206:207], v5 offset:2560
s_waitcnt vmcnt(13)
ds_read_b64_tr_b16 a[208:209], v4 offset:4096
ds_read_b64_tr_b16 a[210:211], v4 offset:4608
ds_read_b64_tr_b16 a[212:213], v5 offset:4096
ds_read_b64_tr_b16 a[214:215], v5 offset:4608
s_waitcnt vmcnt(11)
ds_read_b64_tr_b16 a[216:217], v4 offset:6144
ds_read_b64_tr_b16 a[218:219], v4 offset:6656
ds_read_b64_tr_b16 a[220:221], v5 offset:6144
ds_read_b64_tr_b16 a[222:223], v5 offset:6656
v_mfma_f32_16x16x32_bf16 v[68:71], v[64:67], a[144:147], v[68:71]
s_add_u32 m0, s88, 4096
v_mov_b32 v58, s62
v_mov_b32 v59, s62
v_lshl_add_u32 v9, v1, 3, s88
v_mfma_f32_16x16x32_bf16 v[72:75], v[64:67], a[148:151], v[72:75]
s_add_u32 s79, s89, 4096
v_lshrrev_b32 v51, 4, v1
v_lshrrev_b32 v50, 5, v1
v_mfma_f32_16x16x32_bf16 v[68:71], v[64:67], a[152:155], v[68:71]
buffer_load_dwordx4 v10, s[36:39], s79 offen offset:0 sc1 lds
v_bfe_u32 v52, v1, 2, 3
v_lshl_add_u32 v50, v50, 4, v52
v_mfma_f32_16x16x32_bf16 v[72:75], v[64:67], a[156:159], v[72:75]
buffer_load_dwordx4 v10, s[36:39], s79 offen offset:1024 sc1 lds
v_mul_u32_u24 v50, 896, v50
v_and_b32 v52, 3, v1
v_mfma_f32_16x16x32_bf16 v[68:71], v[64:67], a[160:163], v[68:71]
buffer_load_dwordx4 v10, s[36:39], s79 offen offset:2048 sc1 lds
v_lshl_add_u32 v50, v52, 3, v50
v_add_u32 v77, 75008, v50
v_mfma_f32_16x16x32_bf16 v[72:75], v[64:67], a[164:167], v[72:75]
buffer_load_dwordx4 v10, s[36:39], s79 offen offset:3072 sc1 lds
v_lshlrev_b32 v76, 2, v1
v_and_b32 v76, 0x60, v76
v_cmp_eq_u32 s[80:81], 1, v52
v_mfma_f32_16x16x32_bf16 v[68:71], v[64:67], a[168:171], v[68:71]
s_add_u32 m0, s88, 8192
v_cmp_eq_u32 s[92:93], 2, v52
v_cmp_eq_u32 s[94:95], 3, v52
v_mfma_f32_16x16x32_bf16 v[72:75], v[64:67], a[172:175], v[72:75]
s_add_u32 s79, s89, 8192
v_and_b32 v50, 15, v1
v_lshlrev_b32 v8, 3, v50
s_waitcnt lgkmcnt(15)
v_mfma_f32_16x16x32_bf16 v[68:71], v[64:67], a[176:179], v[68:71]
v_lshrrev_b32 v52, 5, v1
v_lshl_add_u32 v8, v52, 8, v8
v_mfma_f32_16x16x32_bf16 v[72:75], v[64:67], a[180:183], v[72:75]
buffer_load_dwordx4 v10, s[36:39], s79 offen offset:0 sc1 lds
v_and_b32 v52, 1, v51
v_mul_u32_u24 v52, 14464, v52
v_mfma_f32_16x16x32_bf16 v[68:71], v[64:67], a[184:187], v[68:71]
buffer_load_dwordx4 v10, s[36:39], s79 offen offset:1024 sc1 lds
v_add_u32 v8, v8, v52
v_mfma_f32_16x16x32_bf16 v[72:75], v[64:67], a[188:191], v[72:75]
s_lshl_b32 s60, s34, 9
s_add_u32 s60, s60, 161024
v_lshl_add_u32 v62, v50, 5, s60
v_and_b32 v2, 31, v1
s_waitcnt lgkmcnt(14)
v_mfma_f32_16x16x32_bf16 v[68:71], v[64:67], a[192:195], v[68:71]
buffer_load_dwordx4 v10, s[36:39], s79 offen offset:2048 sc1 lds
v_lshlrev_b32 v2, 5, v2
v_add_u32 v2, 161024, v2
s_waitcnt lgkmcnt(12)
v_mfma_f32_16x16x32_bf16 v[72:75], v[64:67], a[196:199], v[72:75]
buffer_load_dwordx4 v10, s[36:39], s79 offen offset:3072 sc1 lds
s_waitcnt lgkmcnt(10)
v_mfma_f32_16x16x32_bf16 v[68:71], v[64:67], a[200:203], v[68:71]
s_mul_i32 s8, s35, 0x9E3779B1
s_add_u32 m0, s88, 12288
s_mov_b32 s9, 0x10001
v_mov_b32 v11, s9
s_waitcnt lgkmcnt(8)
v_mfma_f32_16x16x32_bf16 v[72:75], v[64:67], a[204:207], v[72:75]
s_and_b32 s4, s8, s9
s_add_u32 s79, s89, 12288
s_waitcnt lgkmcnt(6)
v_mfma_f32_16x16x32_bf16 v[68:71], v[64:67], a[208:211], v[68:71]
s_andn2_b32 s5, s9, s8
s_lshr_b32 s8, s8, 1
buffer_load_dwordx4 v10, s[36:39], s79 offen offset:0 sc1 lds
s_and_b32 s6, s8, s9
s_waitcnt lgkmcnt(4)
v_mfma_f32_16x16x32_bf16 v[72:75], v[64:67], a[212:215], v[72:75]
s_lshr_b32 s8, s8, 1
s_and_b32 s7, s8, s9
buffer_load_dwordx4 v10, s[36:39], s79 offen offset:1024 sc1 lds
v_xad_u32 v6, v76, s10, v77
v_xad_u32 v7, v76, s11, v77
s_waitcnt lgkmcnt(2)
v_mfma_f32_16x16x32_bf16 v[68:71], v[64:67], a[216:219], v[68:71]
v_xad_u32 v141, v76, s12, v77
v_xad_u32 v0, v76, s13, v77
s_waitcnt lgkmcnt(0)
v_mfma_f32_16x16x32_bf16 v[72:75], v[64:67], a[220:223], v[72:75]
v_xad_u32 v4, v76, s14, v77
v_xad_u32 v5, v76, s15, v77
v_cmp_gt_u32 vcc, 32, v1
s_nop 1
v_cndmask_b32 v98, 0, v60, vcc
v_mov_b32 v99, 0
v_cvt_pk_bf16_f32 v50, v68, v68
v_and_b32 v51, s65, v50
v_sub_f32 v51, v68, v51
v_cvt_pk_bf16_f32 v96, v68, v51
v_and_b32 v50, 0xffff, v50
v_lshl_or_b32 v97, v98, 16, v50
v_cndmask_b32 v102, 0, v61, vcc
v_mov_b32 v103, 0
v_cvt_pk_bf16_f32 v50, v72, v72
v_and_b32 v51, s65, v50
v_sub_f32 v51, v72, v51
v_cvt_pk_bf16_f32 v100, v72, v51
v_and_b32 v50, 0xffff, v50
v_lshl_or_b32 v101, v102, 16, v50
s_mov_b32 s68, 0
s_barrier
L_h2:
s_waitcnt vmcnt(13)
ds_read_b64_tr_b16 v[16:17], v9 offset:0
ds_read_b64_tr_b16 v[18:19], v9 offset:512
s_waitcnt vmcnt(12)
ds_read_b64_tr_b16 v[20:21], v9 offset:1024
ds_read_b64_tr_b16 v[22:23], v9 offset:1536
s_waitcnt vmcnt(11)
ds_read_b64_tr_b16 v[24:25], v9 offset:2048
ds_read_b64_tr_b16 v[26:27], v9 offset:2560
s_waitcnt lgkmcnt(4)
v_mfma_f32_16x16x32_bf16 v[48:51], v[16:19], v[16:19], 0
v_mfma_f32_16x16x32_bf16 v[52:55], v[56:59], v[16:19], 0
s_waitcnt vmcnt(10)
ds_read_b64_tr_b16 v[28:29], v9 offset:3072
ds_read_b64_tr_b16 v[30:31], v9 offset:3584
s_waitcnt lgkmcnt(4)
v_mfma_f32_16x16x32_bf16 v[48:51], v[20:23], v[20:23], v[48:51]
s_add_u32 s78, s82, 28672
s_add_u32 m0, s83, 0
s_nop 0
buffer_load_dwordx4 v134, s[44:47], s78 offen offset:0 lds
v_mfma_f32_16x16x32_bf16 v[52:55], v[56:59], v[20:23], v[52:55]
s_waitcnt vmcnt(10)
ds_read_b64_tr_b16 v[32:33], v9 offset:4096
ds_read_b64_tr_b16 v[34:35], v9 offset:4608
s_waitcnt lgkmcnt(4)
v_mfma_f32_16x16x32_bf16 v[48:51], v[24:27], v[24:27], v[48:51]
v_mfma_f32_16x16x32_bf16 v[52:55], v[56:59], v[24:27], v[52:55]
s_waitcnt vmcnt(9)
ds_read_b64_tr_b16 v[36:37], v9 offset:5120
ds_read_b64_tr_b16 v[38:39], v9 offset:5632
s_waitcnt lgkmcnt(4)
v_mfma_f32_16x16x32_bf16 v[48:51], v[28:31], v[28:31], v[48:51]
buffer_load_dwordx4 v135, s[44:47], s78 offen offset:1024 lds
v_mfma_f32_16x16x32_bf16 v[52:55], v[56:59], v[28:31], v[52:55]
s_waitcnt vmcnt(9)
ds_read_b64_tr_b16 v[40:41], v9 offset:6144
ds_read_b64_tr_b16 v[42:43], v9 offset:6656
s_waitcnt lgkmcnt(4)
v_mfma_f32_16x16x32_bf16 v[48:51], v[32:35], v[32:35], v[48:51]
v_mfma_f32_16x16x32_bf16 v[52:55], v[56:59], v[32:35], v[52:55]
s_waitcnt vmcnt(8)
ds_read_b64_tr_b16 v[44:45], v9 offset:7168
ds_read_b64_tr_b16 v[46:47], v9 offset:7680
s_waitcnt lgkmcnt(4)
v_mfma_f32_16x16x32_bf16 v[48:51], v[36:39], v[36:39], v[48:51]
buffer_load_dwordx4 v136, s[44:47], s78 offen offset:2048 lds
v_mfma_f32_16x16x32_bf16 v[52:55], v[56:59], v[36:39], v[52:55]
s_waitcnt vmcnt(8)
ds_read_b64_tr_b16 v[16:17], v9 offset:8192
ds_read_b64_tr_b16 v[18:19], v9 offset:8704
s_waitcnt lgkmcnt(4)
v_mfma_f32_16x16x32_bf16 v[48:51], v[40:43], v[40:43], v[48:51]
v_mfma_f32_16x16x32_bf16 v[52:55], v[56:59], v[40:43], v[52:55]
s_waitcnt vmcnt(7)
ds_read_b64_tr_b16 v[20:21], v9 offset:9216
ds_read_b64_tr_b16 v[22:23], v9 offset:9728
s_waitcnt lgkmcnt(4)
v_mfma_f32_16x16x32_bf16 v[48:51], v[44:47], v[44:47], v[48:51]
buffer_load_dwordx4 v137, s[44:47], s78 offen offset:3072 lds
v_mfma_f32_16x16x32_bf16 v[52:55], v[56:59], v[44:47], v[52:55]
s_waitcnt vmcnt(7)
ds_read_b64_tr_b16 v[24:25], v9 offset:10240
ds_read_b64_tr_b16 v[26:27], v9 offset:10752
s_waitcnt lgkmcnt(4)
v_mfma_f32_16x16x32_bf16 v[48:51], v[16:19], v[16:19], v[48:51]
v_mfma_f32_16x16x32_bf16 v[52:55], v[56:59], v[16:19], v[52:55]
s_waitcnt vmcnt(6)
ds_read_b64_tr_b16 v[28:29], v9 offset:11264
ds_read_b64_tr_b16 v[30:31], v9 offset:11776
s_waitcnt lgkmcnt(4)
v_mfma_f32_16x16x32_bf16 v[48:51], v[20:23], v[20:23], v[48:51]
s_add_u32 s78, s82, 32768
s_add_u32 m0, s83, 4096
s_nop 0
buffer_load_dwordx4 v138, s[44:47], s78 offen offset:0 lds
v_mfma_f32_16x16x32_bf16 v[52:55], v[56:59], v[20:23], v[52:55]
s_waitcnt vmcnt(6)
ds_read_b64_tr_b16 v[32:33], v9 offset:12288
ds_read_b64_tr_b16 v[34:35], v9 offset:12800
s_waitcnt lgkmcnt(4)
v_mfma_f32_16x16x32_bf16 v[48:51], v[24:27], v[24:27], v[48:51]
v_mfma_f32_16x16x32_bf16 v[52:55], v[56:59], v[24:27], v[52:55]
s_waitcnt vmcnt(5)
ds_read_b64_tr_b16 v[36:37], v9 offset:13312
ds_read_b64_tr_b16 v[38:39], v9 offset:13824
s_waitcnt lgkmcnt(4)
v_mfma_f32_16x16x32_bf16 v[48:51], v[28:31], v[28:31], v[48:51]
buffer_load_dwordx4 v139, s[44:47], s78 offen offset:1024 lds
v_mfma_f32_16x16x32_bf16 v[52:55], v[56:59], v[28:31], v[52:55]
s_waitcnt lgkmcnt(2)
v_mfma_f32_16x16x32_bf16 v[48:51], v[32:35], v[32:35], v[48:51]
v_mfma_f32_16x16x32_bf16 v[52:55], v[56:59], v[32:35], v[52:55]
s_waitcnt lgkmcnt(0)
v_mfma_f32_16x16x32_bf16 v[48:51], v[36:39], v[36:39], v[48:51]
buffer_load_dwordx4 v140, s[44:47], s78 offen offset:2048 lds
v_mfma_f32_16x16x32_bf16 v[52:55], v[56:59], v[36:39], v[52:55]
s_nop 7
v_cmp_u_f32 vcc, v52, v52
s_cbranch_vccnz L_h2re
L_h2ok:
s_barrier
ds_read_b64_tr_b16 v[80:81], v8 offset:0
ds_read_b64_tr_b16 v[82:83], v8 offset:128
ds_read_b64_tr_b16 v[84:85], v8 offset:512
ds_read_b64_tr_b16 v[86:87], v8 offset:640
ds_read_b64_tr_b16 v[88:89], v8 offset:1024
ds_read_b64_tr_b16 v[90:91], v8 offset:1152
ds_read_b64_tr_b16 v[92:93], v8 offset:1536
ds_read_b64_tr_b16 v[94:95], v8 offset:1664
ds_read_b64_tr_b16 v[152:153], v8 offset:2048
ds_read_b64_tr_b16 v[154:155], v8 offset:2176
ds_read_b64_tr_b16 v[156:157], v8 offset:2560
ds_read_b64_tr_b16 v[158:159], v8 offset:2688
v_xad_u32 v9, v76, s90, v77
v_cndmask_b32 v48, v48, v49, s[80:81]
v_cndmask_b32 v48, v48, v50, s[92:93]
v_cndmask_b32 v48, v48, v51, s[94:95]
v_mul_f32 v52, 0xbb124925, v52
v_mul_f32 v48, 0x3b124925, v48
v_fma_f32 v48, -v52, v52, v48
v_max_f32 v48, 0, v48
v_mov_b32 v49, 0x2edbe6ff
v_fmac_f32 v49, 0x3f800054, v48
v_rsq_f32 v50, v49
v_sqrt_f32 v68, v49
v_cvt_pk_bf16_f32 v64, v52, v52
v_and_b32 v51, s65, v64
v_sub_f32 v51, v52, v51
v_cvt_pk_bf16_f32 v65, v51, v68
v_and_b32 v51, s65, v65
v_sub_f32 v51, v68, v51
v_mov_b32 v67, 0
v_cvt_pk_bf16_f32 v66, v51, v67
v_mul_f32 v69, 0xc0135761, v50
v_mul_f32 v50, v50, v50
v_mul_f32 v50, 0x3d372713, v50
v_mul_f32 v70, v69, v50
s_mov_b32 exec_lo, 0x00f0000f
s_mov_b32 exec_hi, 0xf0000f00
ds_write_b128 v62, v[64:67]
ds_write_b128 v62, v[68:71] offset:16
s_mov_b64 exec, -1
s_waitcnt lgkmcnt(12)
v_mfma_f32_32x32x16_bf16 v[16:31], a[0:3], v[80:83], 0
ds_read_b64_tr_b16 v[160:161], v8 offset:3072
s_add_u32 s78, s82, 57344
s_add_u32 m0, s83, 28672
s_nop 0
buffer_load_dwordx4 v134, s[44:47], s78 offen offset:0 lds
ds_read_b64_tr_b16 a[224:225], v6 offset:57344
v_lshrrev_b32 v78, 4, v1
v_lshl_add_u32 v79, v78, 3, s90
v_mfma_f32_32x32x16_bf16 v[32:47], a[4:7], v[80:83], 0
ds_read_b64_tr_b16 a[226:227], v6 offset:64512
ds_read_b64_tr_b16 v[162:163], v8 offset:3200
global_load_dwordx2 v[150:151], v79, s[26:27]
s_waitcnt lgkmcnt(14)
v_mfma_f32_32x32x16_bf16 v[16:31], a[8:11], v[84:87], v[16:31]
ds_read_b64_tr_b16 a[228:229], v7 offset:57344
ds_read_b64_tr_b16 v[164:165], v8 offset:3584
buffer_load_dwordx4 v135, s[44:47], s78 offen offset:1024 lds
s_lshl_b32 s60, s90, 4
ds_read_b64_tr_b16 a[230:231], v7 offset:64512
v_lshl_add_u32 v3, v1, 3, s60
v_mfma_f32_32x32x16_bf16 v[32:47], a[12:15], v[84:87], v[32:47]
ds_read_b64_tr_b16 v[166:167], v8 offset:3712
ds_read_b64_tr_b16 a[232:233], v141 offset:57344
s_waitcnt lgkmcnt(15)
v_mfma_f32_32x32x16_bf16 v[16:31], a[16:19], v[88:91], v[16:31]
s_lshl_b32 s60, s34, 12
ds_read_b64_tr_b16 a[234:235], v141 offset:64512
ds_read_b64_tr_b16 v[80:81], v8 offset:4096
buffer_load_dwordx4 v136, s[44:47], s78 offen offset:2048 lds
s_add_u32 s60, s60, 32768
v_mfma_f32_32x32x16_bf16 v[32:47], a[20:23], v[88:91], v[32:47]
ds_read_b64_tr_b16 a[236:237], v0 offset:57344
ds_read_b64_tr_b16 v[82:83], v8 offset:4224
v_add_u32 v12, s60, v10
v_and_b32 v79, 15, v1
v_mfma_f32_32x32x16_bf16 v[16:31], a[24:27], v[92:95], v[16:31]
ds_read_b64_tr_b16 a[238:239], v0 offset:64512
ds_read_b64_tr_b16 v[84:85], v8 offset:4608
buffer_load_dwordx4 v137, s[44:47], s78 offen offset:3072 lds
ds_read_b64_tr_b16 a[240:241], v4 offset:57344
v_lshlrev_b32 v13, 4, v79
v_mfma_f32_32x32x16_bf16 v[32:47], a[28:31], v[92:95], v[32:47]
ds_read_b64_tr_b16 v[86:87], v8 offset:4736
ds_read_b64_tr_b16 a[242:243], v4 offset:64512
s_add_u32 s78, s82, 61440
s_add_u32 m0, s83, 32768
v_lshl_add_u32 v13, v78, 9, v13
s_waitcnt lgkmcnt(10)
v_mfma_f32_32x32x16_bf16 v[16:31], a[32:35], v[152:155], v[16:31]
ds_read_b64_tr_b16 a[244:245], v5 offset:57344
ds_read_b64_tr_b16 v[88:89], v8 offset:5120
buffer_load_dwordx4 v138, s[44:47], s78 offen offset:0 lds
v_add_u32 v13, 32768, v13
v_and_b32 v79, 31, v1
v_mfma_f32_32x32x16_bf16 v[32:47], a[36:39], v[152:155], v[32:47]
ds_read_b64_tr_b16 a[246:247], v5 offset:64512
ds_read_b64_tr_b16 v[90:91], v8 offset:5248
ds_read_b64_tr_b16 a[248:249], v9 offset:57344
v_and_b32 v78, 2, v78
v_mfma_f32_32x32x16_bf16 v[16:31], a[40:43], v[156:159], v[16:31]
ds_read_b64_tr_b16 v[92:93], v8 offset:5632
buffer_load_dwordx4 v139, s[44:47], s78 offen offset:1024 lds
ds_read_b64_tr_b16 a[250:251], v9 offset:64512
v_mul_u32_u24 v14, 896, v79
v_mfma_f32_32x32x16_bf16 v[32:47], a[44:47], v[156:159], v[32:47]
ds_read_b64_tr_b16 v[94:95], v8 offset:5760
v_lshl_add_u32 v14, v78, 3, v14
v_mfma_f32_32x32x16_bf16 v[16:31], a[48:51], v[160:163], v[16:31]
s_mul_i32 s91, s59, 53248
ds_read_b64_tr_b16 v[152:153], v8 offset:6144
buffer_load_dwordx4 v140, s[44:47], s78 offen offset:2048 lds
v_mfma_f32_32x32x16_bf16 v[32:47], a[52:55], v[160:163], v[32:47]
s_sub_u32 s91, s73, s91
ds_read_b64_tr_b16 v[154:155], v8 offset:6272
s_add_u32 s60, s59, 6
v_mfma_f32_32x32x16_bf16 v[16:31], a[56:59], v[164:167], v[16:31]
ds_read_b64_tr_b16 v[156:157], v8 offset:6656
s_waitcnt vmcnt(8)
s_waitcnt lgkmcnt(4)
s_barrier
s_add_u32 s78, s82, 86016
s_add_u32 m0, s83, 57344
s_nop 0
buffer_load_dwordx4 v134, s[44:47], s78 offen offset:0 lds
s_sub_u32 s61, s60, 7
v_mfma_f32_32x32x16_bf16 v[32:47], a[60:63], v[164:167], v[32:47]
s_min_u32 s60, s60, s61
ds_read_b64_tr_b16 v[158:159], v8 offset:6784
ds_read_b64_tr_b16 v[172:173], v6 offset:0
s_waitcnt lgkmcnt(5)
v_mfma_f32_32x32x16_bf16 v[16:31], a[64:67], v[80:83], v[16:31]
s_mul_i32 s60, s60, 53248
ds_read_b64_tr_b16 v[174:175], v6 offset:7168
ds_read_b64_tr_b16 v[160:161], v8 offset:7168
buffer_load_dwordx4 v135, s[44:47], s78 offen offset:1024 lds
s_add_u32 s60, s60, 0
v_mfma_f32_32x32x16_bf16 v[32:47], a[68:71], v[80:83], v[32:47]
ds_read_b64_tr_b16 v[176:177], v7 offset:0
ds_read_b64_tr_b16 v[162:163], v8 offset:7296
s_add_u32 s92, s91, s60
ds_read_b64_tr_b16 v[178:179], v7 offset:7168
v_mfma_f32_32x32x16_bf16 v[16:31], a[72:75], v[84:87], v[16:31]
s_add_u32 s60, s59, 5
ds_read_b64_tr_b16 v[164:165], v8 offset:7680
buffer_load_dwordx4 v136, s[44:47], s78 offen offset:2048 lds
ds_read_b64_tr_b16 v[180:181], v141 offset:0
v_mfma_f32_32x32x16_bf16 v[32:47], a[76:79], v[84:87], v[32:47]
s_sub_u32 s61, s60, 7
ds_read_b64_tr_b16 v[182:183], v141 offset:7168
ds_read_b64_tr_b16 v[166:167], v8 offset:7808
s_min_u32 s60, s60, s61
v_mfma_f32_32x32x16_bf16 v[16:31], a[80:83], v[88:91], v[16:31]
ds_read_b64_tr_b16 v[184:185], v0 offset:0
ds_read_b64_tr_b16 v[80:81], v8 offset:8192
buffer_load_dwordx4 v137, s[44:47], s78 offen offset:3072 lds
s_mul_i32 s60, s60, 53248
v_mfma_f32_32x32x16_bf16 v[32:47], a[84:87], v[88:91], v[32:47]
ds_read_b64_tr_b16 v[186:187], v0 offset:7168
s_add_u32 s60, s60, 2048
ds_read_b64_tr_b16 v[82:83], v8 offset:8320
ds_read_b64_tr_b16 v[188:189], v4 offset:0
s_add_u32 s78, s82, 90112
s_add_u32 m0, s83, 61440
v_mfma_f32_32x32x16_bf16 v[16:31], a[88:91], v[92:95], v[16:31]
s_add_u32 s93, s91, s60
ds_read_b64_tr_b16 v[84:85], v8 offset:8704
buffer_load_dwordx4 v138, s[44:47], s78 offen offset:0 lds
ds_read_b64_tr_b16 v[190:191], v4 offset:7168
s_add_u32 s60, s59, 4
v_mfma_f32_32x32x16_bf16 v[32:47], a[92:95], v[92:95], v[32:47]
ds_read_b64_tr_b16 v[192:193], v5 offset:0
ds_read_b64_tr_b16 v[86:87], v8 offset:8832
s_sub_u32 s61, s60, 7
s_waitcnt lgkmcnt(9)
v_mfma_f32_32x32x16_bf16 v[16:31], a[96:99], v[152:155], v[16:31]
ds_read_b64_tr_b16 v[194:195], v5 offset:7168
s_min_u32 s60, s60, s61
ds_read_b64_tr_b16 v[88:89], v8 offset:9216
buffer_load_dwordx4 v139, s[44:47], s78 offen offset:1024 lds
ds_read_b64_tr_b16 v[196:197], v9 offset:0
v_mfma_f32_32x32x16_bf16 v[32:47], a[100:103], v[152:155], v[32:47]
s_mul_i32 s60, s60, 53248
ds_read_b64_tr_b16 v[90:91], v8 offset:9344
ds_read_b64_tr_b16 v[198:199], v9 offset:7168
s_add_u32 s60, s60, 4096
v_mfma_f32_32x32x16_bf16 v[16:31], a[104:107], v[156:159], v[16:31]
ds_read_b64_tr_b16 v[92:93], v8 offset:9728
buffer_load_dwordx4 v140, s[44:47], s78 offen offset:2048 lds
s_add_u32 s94, s91, s60
v_mfma_f32_32x32x16_bf16 v[32:47], a[108:111], v[156:159], v[32:47]
s_add_u32 s60, s59, 3
ds_read_b64_tr_b16 v[94:95], v8 offset:9856
v_mfma_f32_32x32x16_bf16 v[16:31], a[112:115], v[160:163], v[16:31]
s_sub_u32 s61, s60, 7
ds_read_b64_tr_b16 v[152:153], v8 offset:10240
s_waitcnt vmcnt(7)
s_waitcnt lgkmcnt(3)
s_barrier
s_add_u32 s78, s82, 114688
s_add_u32 m0, s83, 0
s_nop 0
buffer_load_dwordx4 v134, s[44:47], s78 offen offset:0 lds
s_min_u32 s60, s60, s61
v_mfma_f32_32x32x16_bf16 v[32:47], a[116:119], v[160:163], v[32:47]
ds_read_b64_tr_b16 v[154:155], v8 offset:10368
ds_read_b64_tr_b16 v[200:201], v6 offset:28672
s_mul_i32 s60, s60, 53248
v_mfma_f32_32x32x16_bf16 v[16:31], a[120:123], v[164:167], v[16:31]
ds_read_b64_tr_b16 v[202:203], v6 offset:35840
s_add_u32 s60, s60, 6144
ds_read_b64_tr_b16 v[156:157], v8 offset:10752
ds_read_b64_tr_b16 v[204:205], v7 offset:28672
buffer_load_dwordx4 v135, s[44:47], s78 offen offset:1024 lds
v_mfma_f32_32x32x16_bf16 v[32:47], a[124:127], v[164:167], v[32:47]
s_add_u32 s95, s91, s60
ds_read_b64_tr_b16 v[206:207], v7 offset:35840
ds_read_b64_tr_b16 v[158:159], v8 offset:10880
s_add_u32 s60, s59, 2
s_waitcnt lgkmcnt(8)
v_mfma_f32_32x32x16_bf16 v[16:31], a[128:131], v[80:83], v[16:31]
ds_read_b64_tr_b16 v[208:209], v141 offset:28672
ds_read_b64_tr_b16 v[160:161], v8 offset:11264
s_sub_u32 s61, s60, 7
ds_read_b64_tr_b16 v[210:211], v141 offset:35840
v_mfma_f32_32x32x16_bf16 v[32:47], a[132:135], v[80:83], v[32:47]
buffer_load_dwordx4 v136, s[44:47], s78 offen offset:2048 lds
s_min_u32 s60, s60, s61
ds_read_b64_tr_b16 v[212:213], v0 offset:28672
ds_read_b64_tr_b16 v[162:163], v8 offset:11392
ds_read_b64_tr_b16 v[214:215], v0 offset:35840
v_mfma_f32_32x32x16_bf16 v[16:31], a[136:139], v[84:87], v[16:31]
s_mul_i32 s60, s60, 53248
ds_read_b64_tr_b16 v[164:165], v8 offset:11776
ds_read_b64_tr_b16 v[216:217], v4 offset:28672
s_add_u32 s60, s60, 8192
v_mfma_f32_32x32x16_bf16 v[32:47], a[140:143], v[84:87], v[32:47]
ds_read_b64_tr_b16 v[218:219], v4 offset:35840
buffer_load_dwordx4 v137, s[44:47], s78 offen offset:3072 lds
ds_read_b64_tr_b16 v[166:167], v8 offset:11904
s_add_u32 s96, s91, s60
ds_read_b64_tr_b16 v[220:221], v5 offset:28672
v_mfma_f32_32x32x16_bf16 v[16:31], a[144:147], v[88:91], v[16:31]
s_add_u32 s60, s59, 1
ds_read_b64_tr_b16 v[80:81], v8 offset:12288
ds_read_b64_tr_b16 v[222:223], v5 offset:35840
v_mfma_f32_32x32x16_bf16 v[32:47], a[148:151], v[88:91], v[32:47]
s_sub_u32 s61, s60, 7
s_add_u32 s78, s82, 118784
s_add_u32 m0, s83, 4096
ds_read_b64_tr_b16 v[224:225], v9 offset:28672
ds_read_b64_tr_b16 v[82:83], v8 offset:12416
buffer_load_dwordx4 v138, s[44:47], s78 offen offset:0 lds
ds_read_b64_tr_b16 v[226:227], v9 offset:35840
s_min_u32 s60, s60, s61
v_mfma_f32_32x32x16_bf16 v[16:31], a[152:155], v[92:95], v[16:31]
ds_read_b128 v[104:107], v2 offset:0
ds_read_b64_tr_b16 v[84:85], v8 offset:12800
s_mul_i32 s60, s60, 53248
v_mfma_f32_32x32x16_bf16 v[32:47], a[156:159], v[92:95], v[32:47]
ds_read_b128 v[112:115], v2 offset:16
s_add_u32 s60, s60, 10240
ds_read_b64_tr_b16 v[86:87], v8 offset:12928
ds_read_b128 v[108:111], v2 offset:1024
buffer_load_dwordx4 v139, s[44:47], s78 offen offset:1024 lds
s_waitcnt lgkmcnt(11)
v_mfma_f32_32x32x16_bf16 v[16:31], a[160:163], v[152:155], v[16:31]
s_add_u32 s97, s91, s60
ds_read_b128 v[116:119], v2 offset:1040
ds_read_b64_tr_b16 v[88:89], v8 offset:13312
s_lshl_b32 s60, s58, 6
ds_read_b64_tr_b16 v[142:143], v3 offset:0
v_mfma_f32_32x32x16_bf16 v[32:47], a[164:167], v[152:155], v[32:47]
ds_read_b64_tr_b16 v[90:91], v8 offset:13440
s_mul_i32 s60, s60, 896
ds_read_b64_tr_b16 v[144:145], v3 offset:14464
v_mfma_f32_32x32x16_bf16 v[16:31], a[168:171], v[156:159], v[16:31]
buffer_load_dwordx4 v140, s[44:47], s78 offen offset:2048 lds
ds_read_b64_tr_b16 v[146:147], v3 offset:28928
s_add_u32 s90, s90, s60
ds_read_b64_tr_b16 v[92:93], v8 offset:13824
ds_read_b64_tr_b16 v[148:149], v3 offset:43392
v_mfma_f32_32x32x16_bf16 v[32:47], a[172:175], v[156:159], v[32:47]
s_mov_b32 s98, 0x3f80
ds_read_b64_tr_b16 v[94:95], v8 offset:13952
s_mov_b32 s99, 0x3f800000
v_mfma_f32_32x32x16_bf16 v[16:31], a[176:179], v[160:163], v[16:31]
ds_read_b64_tr_b16 v[152:153], v8 offset:28928
s_waitcnt vmcnt(7)
s_waitcnt lgkmcnt(15)
s_barrier
s_add_u32 s78, s82, 143360
s_add_u32 m0, s83, 28672
s_nop 0
buffer_load_dwordx4 v134, s[44:47], s78 offen offset:0 lds
v_mfma_f32_32x32x16_bf16 v[32:47], a[180:183], v[160:163], v[32:47]
ds_read_b64_tr_b16 v[154:155], v8 offset:29056
ds_read_b64_tr_b16 v[228:229], v6 offset:57344
v_mfma_f32_32x32x16_bf16 v[16:31], a[184:187], v[164:167], v[16:31]
ds_read_b64_tr_b16 v[156:157], v8 offset:29440
ds_read_b64_tr_b16 v[230:231], v6 offset:64512
v_mfma_f32_32x32x16_bf16 v[32:47], a[188:191], v[164:167], v[32:47]
ds_read_b64_tr_b16 v[158:159], v8 offset:29568
buffer_load_dwordx4 v135, s[44:47], s78 offen offset:1024 lds
ds_read_b64_tr_b16 v[232:233], v7 offset:57344
s_waitcnt lgkmcnt(7)
v_mfma_f32_32x32x16_bf16 v[16:31], a[192:195], v[80:83], v[16:31]
ds_read_b64_tr_b16 v[160:161], v8 offset:29952
ds_read_b64_tr_b16 v[234:235], v7 offset:64512
v_mfma_f32_32x32x16_bf16 v[32:47], a[196:199], v[80:83], v[32:47]
ds_read_b64_tr_b16 v[162:163], v8 offset:30080
ds_read_b64_tr_b16 v[236:237], v141 offset:57344
v_mfma_f32_32x32x16_bf16 v[16:31], a[200:203], v[84:87], v[16:31]
ds_read_b64_tr_b16 v[164:165], v8 offset:30464
buffer_load_dwordx4 v136, s[44:47], s78 offen offset:2048 lds
ds_read_b64_tr_b16 v[238:239], v141 offset:64512
v_mfma_f32_32x32x16_bf16 v[32:47], a[204:207], v[84:87], v[32:47]
ds_read_b64_tr_b16 v[166:167], v8 offset:30592
ds_read_b64_tr_b16 v[240:241], v0 offset:57344
v_mfma_f32_32x32x16_bf16 v[16:31], a[208:211], v[88:91], v[16:31]
ds_read_b64_tr_b16 v[80:81], v8 offset:30976
v_mfma_f32_32x32x16_bf16 v[32:47], a[212:215], v[88:91], v[32:47]
ds_read_b64_tr_b16 v[242:243], v0 offset:64512
ds_read_b64_tr_b16 v[82:83], v8 offset:31104
buffer_load_dwordx4 v137, s[44:47], s78 offen offset:3072 lds
v_mfma_f32_32x32x16_bf16 v[16:31], a[216:219], v[92:95], v[16:31]
ds_read_b64_tr_b16 v[244:245], v4 offset:57344
ds_read_b64_tr_b16 v[84:85], v8 offset:31488
v_mfma_f32_32x32x16_bf16 v[32:47], a[220:223], v[92:95], v[32:47]
ds_read_b64_tr_b16 v[246:247], v4 offset:64512
ds_read_b64_tr_b16 v[86:87], v8 offset:31616
v_mfma_f32_32x32x16_bf16 v[16:31], v[96:99], v[104:107], v[16:31]
ds_read_b64_tr_b16 v[248:249], v5 offset:57344
s_add_u32 s78, s82, 147456
s_add_u32 m0, s83, 32768
v_mfma_f32_32x32x16_bf16 v[32:47], v[100:103], v[104:107], v[32:47]
buffer_load_dwordx4 v138, s[44:47], s78 offen offset:0 lds
ds_read_b64_tr_b16 v[250:251], v5 offset:64512
s_waitcnt lgkmcnt(10)
v_mfma_f32_32x32x16_bf16 v[48:63], a[0:3], v[152:155], 0
ds_read_b64_tr_b16 v[252:253], v9 offset:57344
ds_read_b64_tr_b16 v[88:89], v8 offset:32000
v_mfma_f32_32x32x16_bf16 v[64:79], a[4:7], v[152:155], 0
ds_read_b64_tr_b16 v[254:255], v9 offset:64512
ds_read_b64_tr_b16 v[90:91], v8 offset:32128
v_mfma_f32_32x32x16_bf16 v[48:63], a[8:11], v[156:159], v[48:63]
buffer_load_dwordx4 v139, s[44:47], s78 offen offset:1024 lds
ds_read_b64_tr_b16 v[92:93], v8 offset:32512
v_mul_f32 v120, v16, v16
v_mul_f32 v121, v17, v17
v_fma_f32 v120, v120, v114, v113
v_fma_f32 v121, v121, v114, v113
v_mul_f32 v120, v120, v16
v_mul_f32 v121, v121, v17
v_mfma_f32_32x32x16_bf16 v[64:79], a[12:15], v[156:159], v[64:79]
ds_read_b64_tr_b16 v[94:95], v8 offset:32640
v_exp_f32 v120, v120
v_exp_f32 v121, v121
v_fma_f32 v120, v120, v112, v112
v_fma_f32 v121, v121, v112, v112
v_mfma_f32_32x32x16_bf16 v[48:63], a[16:19], v[160:163], v[48:63]
ds_read_b64_tr_b16 v[152:153], v8 offset:33024
v_rcp_f32 v120, v120
v_rcp_f32 v121, v121
v_mul_f32 v120, v120, v16
v_mfma_f32_32x32x16_bf16 v[64:79], a[20:23], v[160:163], v[64:79]
buffer_load_dwordx4 v140, s[44:47], s78 offen offset:2048 lds
ds_read_b64_tr_b16 v[154:155], v8 offset:33152
v_mul_f32 v121, v121, v17
v_cvt_pk_bf16_f32 v126, v120, v121
v_mul_f32 v122, v18, v18
v_mul_f32 v123, v19, v19
v_fma_f32 v122, v122, v114, v113
v_fma_f32 v123, v123, v114, v113
v_mfma_f32_32x32x16_bf16 v[48:63], a[24:27], v[164:167], v[48:63]
ds_read_b64_tr_b16 v[156:157], v8 offset:33536
v_mul_f32 v122, v122, v18
v_mul_f32 v123, v123, v19
v_exp_f32 v122, v122
v_exp_f32 v123, v123
v_mfma_f32_32x32x16_bf16 v[64:79], a[28:31], v[164:167], v[64:79]
ds_read_b64_tr_b16 v[158:159], v8 offset:33664
v_fma_f32 v122, v122, v112, v112
v_fma_f32 v123, v123, v112, v112
v_rcp_f32 v122, v122
v_rcp_f32 v123, v123
s_waitcnt lgkmcnt(4)
v_mfma_f32_32x32x16_bf16 v[48:63], a[32:35], v[80:83], v[48:63]
ds_read_b64_tr_b16 v[160:161], v8 offset:34048
s_waitcnt vmcnt(7)
s_barrier
s_add_u32 s78, s82, 172032
s_add_u32 m0, s83, 57344
s_nop 0
buffer_load_dwordx4 v134, s[44:47], s78 offen offset:0 lds
v_mul_f32 v122, v122, v18
v_mul_f32 v123, v123, v19
v_cvt_pk_bf16_f32 v127, v122, v123
v_mul_f32 v120, v20, v20
v_mul_f32 v121, v21, v21
v_mfma_f32_32x32x16_bf16 v[64:79], a[36:39], v[80:83], v[64:79]
ds_read_b64_tr_b16 v[162:163], v8 offset:34176
ds_read_b64_tr_b16 a[0:1], v6 offset:0
v_fma_f32 v120, v120, v114, v113
v_fma_f32 v121, v121, v114, v113
v_mul_f32 v120, v120, v20
v_mul_f32 v121, v121, v21
v_exp_f32 v120, v120
v_mfma_f32_32x32x16_bf16 v[48:63], a[40:43], v[84:87], v[48:63]
ds_read_b64_tr_b16 v[164:165], v8 offset:34560
v_exp_f32 v121, v121
v_fma_f32 v120, v120, v112, v112
v_fma_f32 v121, v121, v112, v112
v_rcp_f32 v120, v120
v_mfma_f32_32x32x16_bf16 v[64:79], a[44:47], v[84:87], v[64:79]
ds_read_b64_tr_b16 a[2:3], v6 offset:7168
ds_read_b64_tr_b16 v[166:167], v8 offset:34688
buffer_load_dwordx4 v135, s[44:47], s78 offen offset:1024 lds
v_rcp_f32 v121, v121
v_mul_f32 v120, v120, v20
v_mul_f32 v121, v121, v21
v_mfma_f32_32x32x16_bf16 v[48:63], a[48:51], v[88:91], v[48:63]
ds_read_b64_tr_b16 v[80:81], v8 offset:35072
ds_read_b64_tr_b16 a[4:5], v7 offset:0
v_cvt_pk_bf16_f32 v128, v120, v121
v_mul_f32 v122, v22, v22
v_mul_f32 v123, v23, v23
v_fma_f32 v122, v122, v114, v113
v_fma_f32 v123, v123, v114, v113
v_mul_f32 v122, v122, v22
v_mfma_f32_32x32x16_bf16 v[64:79], a[52:55], v[88:91], v[64:79]
ds_read_b64_tr_b16 v[82:83], v8 offset:35200
v_mul_f32 v123, v123, v23
v_exp_f32 v122, v122
v_exp_f32 v123, v123
v_fma_f32 v122, v122, v112, v112
v_mfma_f32_32x32x16_bf16 v[48:63], a[56:59], v[92:95], v[48:63]
ds_read_b64_tr_b16 a[6:7], v7 offset:7168
ds_read_b64_tr_b16 v[84:85], v8 offset:35584
v_fma_f32 v123, v123, v112, v112
v_rcp_f32 v122, v122
v_rcp_f32 v123, v123
v_mfma_f32_32x32x16_bf16 v[64:79], a[60:63], v[92:95], v[64:79]
buffer_load_dwordx4 v136, s[44:47], s78 offen offset:2048 lds
ds_read_b64_tr_b16 v[86:87], v8 offset:35712
ds_read_b64_tr_b16 a[8:9], v141 offset:0
v_mul_f32 v122, v122, v22
v_mul_f32 v123, v123, v23
v_cvt_pk_bf16_f32 v129, v122, v123
v_mul_f32 v120, v24, v24
v_mul_f32 v121, v25, v25
s_waitcnt lgkmcnt(7)
v_mfma_f32_32x32x16_bf16 v[48:63], a[64:67], v[152:155], v[48:63]
ds_write_b128 v12, v[126:129] offset:25088
ds_read_b64_tr_b16 v[88:89], v8 offset:36096
ds_read_b64_tr_b16 a[10:11], v141 offset:7168
v_mfma_f32_32x32x16_bf16 v[64:79], a[68:71], v[152:155], v[64:79]
ds_read_b64_tr_b16 v[90:91], v8 offset:36224
v_mfma_f32_32x32x16_bf16 v[48:63], a[72:75], v[156:159], v[48:63]
ds_read_b64_tr_b16 v[92:93], v8 offset:36608
ds_read_b64_tr_b16 a[12:13], v0 offset:0
buffer_load_dwordx4 v137, s[44:47], s78 offen offset:3072 lds
v_fma_f32 v120, v120, v114, v113
v_fma_f32 v121, v121, v114, v113
v_mul_f32 v120, v120, v24
v_mul_f32 v121, v121, v25
v_exp_f32 v120, v120
v_exp_f32 v121, v121
v_fma_f32 v120, v120, v112, v112
v_fma_f32 v121, v121, v112, v112
v_rcp_f32 v120, v120
v_rcp_f32 v121, v121
v_mul_f32 v120, v120, v24
v_mul_f32 v121, v121, v25
v_cvt_pk_bf16_f32 v130, v120, v121
v_mfma_f32_32x32x16_bf16 v[64:79], a[76:79], v[156:159], v[64:79]
ds_read_b64_tr_b16 v[94:95], v8 offset:36736
v_mul_f32 v122, v26, v26
v_mul_f32 v123, v27, v27
v_fma_f32 v122, v122, v114, v113
v_fma_f32 v123, v123, v114, v113
v_mul_f32 v122, v122, v26
v_mfma_f32_32x32x16_bf16 v[48:63], a[80:83], v[160:163], v[48:63]
ds_read_b64_tr_b16 a[14:15], v0 offset:7168
ds_read_b64_tr_b16 v[152:153], v8 offset:37120
v_mul_f32 v123, v123, v27
v_exp_f32 v122, v122
v_exp_f32 v123, v123
v_fma_f32 v122, v122, v112, v112
v_mfma_f32_32x32x16_bf16 v[64:79], a[84:87], v[160:163], v[64:79]
ds_read_b64_tr_b16 v[154:155], v8 offset:37248
ds_read_b64_tr_b16 a[16:17], v4 offset:0
s_add_u32 s78, s82, 176128
s_add_u32 m0, s83, 61440
v_fma_f32 v123, v123, v112, v112
v_rcp_f32 v122, v122
v_rcp_f32 v123, v123
v_mfma_f32_32x32x16_bf16 v[48:63], a[88:91], v[164:167], v[48:63]
buffer_load_dwordx4 v138, s[44:47], s78 offen offset:0 lds
ds_read_b64_tr_b16 v[156:157], v8 offset:37632
v_mul_f32 v122, v122, v26
v_mul_f32 v123, v123, v27
v_cvt_pk_bf16_f32 v131, v122, v123
v_mul_f32 v120, v28, v28
v_mul_f32 v121, v29, v29
v_fma_f32 v120, v120, v114, v113
v_mfma_f32_32x32x16_bf16 v[64:79], a[92:95], v[164:167], v[64:79]
ds_read_b64_tr_b16 a[18:19], v4 offset:7168
ds_read_b64_tr_b16 v[158:159], v8 offset:37760
v_fma_f32 v121, v121, v114, v113
v_mul_f32 v120, v120, v28
v_mul_f32 v121, v121, v29
v_exp_f32 v120, v120
v_exp_f32 v121, v121
s_waitcnt lgkmcnt(7)
v_mfma_f32_32x32x16_bf16 v[48:63], a[96:99], v[80:83], v[48:63]
ds_read_b64_tr_b16 v[160:161], v8 offset:38144
ds_read_b64_tr_b16 a[20:21], v5 offset:0
v_fma_f32 v120, v120, v112, v112
v_fma_f32 v121, v121, v112, v112
v_rcp_f32 v120, v120
v_mfma_f32_32x32x16_bf16 v[64:79], a[100:103], v[80:83], v[64:79]
ds_read_b64_tr_b16 v[162:163], v8 offset:38272
buffer_load_dwordx4 v139, s[44:47], s78 offen offset:1024 lds
v_rcp_f32 v121, v121
v_mul_f32 v120, v120, v28
v_mul_f32 v121, v121, v29
v_cvt_pk_bf16_f32 v132, v120, v121
v_mul_f32 v122, v30, v30
v_mfma_f32_32x32x16_bf16 v[48:63], a[104:107], v[84:87], v[48:63]
ds_read_b64_tr_b16 a[22:23], v5 offset:7168
ds_read_b64_tr_b16 v[164:165], v8 offset:38656
v_mul_f32 v123, v31, v31
v_fma_f32 v122, v122, v114, v113
v_fma_f32 v123, v123, v114, v113
v_mul_f32 v122, v122, v30
v_mul_f32 v123, v123, v31
v_mfma_f32_32x32x16_bf16 v[64:79], a[108:111], v[84:87], v[64:79]
ds_read_b64_tr_b16 v[166:167], v8 offset:38784
ds_read_b64_tr_b16 a[24:25], v9 offset:0
v_exp_f32 v122, v122
v_exp_f32 v123, v123
v_fma_f32 v122, v122, v112, v112
v_fma_f32 v123, v123, v112, v112
v_mfma_f32_32x32x16_bf16 v[48:63], a[112:115], v[88:91], v[48:63]
ds_read_b64_tr_b16 v[80:81], v8 offset:39168
v_rcp_f32 v122, v122
v_rcp_f32 v123, v123
v_mul_f32 v122, v122, v30
v_mul_f32 v123, v123, v31
v_mfma_f32_32x32x16_bf16 v[64:79], a[116:119], v[88:91], v[64:79]
ds_read_b64_tr_b16 a[26:27], v9 offset:7168
buffer_load_dwordx4 v140, s[44:47], s78 offen offset:2048 lds
ds_read_b64_tr_b16 v[82:83], v8 offset:39296
v_cvt_pk_bf16_f32 v133, v122, v123
v_mul_f32 v120, v32, v32
v_mul_f32 v121, v33, v33
v_fma_f32 v120, v120, v114, v113
v_mfma_f32_32x32x16_bf16 v[48:63], a[120:123], v[92:95], v[48:63]
ds_write_b128 v12, v[130:133] offset:26112
ds_read_b64_tr_b16 v[84:85], v8 offset:39680
v_mfma_f32_32x32x16_bf16 v[64:79], a[124:127], v[92:95], v[64:79]
ds_read_b64_tr_b16 v[86:87], v8 offset:39808
s_waitcnt lgkmcnt(7)
v_mfma_f32_32x32x16_bf16 v[48:63], a[128:131], v[152:155], v[48:63]
ds_read_b64_tr_b16 v[88:89], v8 offset:40192
s_waitcnt lgkmcnt(5)
s_waitcnt lgkmcnt(3)
s_barrier
s_add_u32 s78, s82, 200704
s_add_u32 m0, s83, 0
s_nop 0
buffer_load_dwordx4 v134, s[44:47], s78 offen offset:0 lds
v_fma_f32 v121, v121, v114, v113
v_mul_f32 v120, v120, v32
v_mul_f32 v121, v121, v33
v_exp_f32 v120, v120
v_exp_f32 v121, v121
v_fma_f32 v120, v120, v112, v112
v_fma_f32 v121, v121, v112, v112
v_rcp_f32 v120, v120
v_rcp_f32 v121, v121
v_mul_f32 v120, v120, v32
v_mul_f32 v121, v121, v33
v_cvt_pk_bf16_f32 v126, v120, v121
v_mul_f32 v122, v34, v34
v_mfma_f32_32x32x16_bf16 v[64:79], a[132:135], v[152:155], v[64:79]
ds_read_b64_tr_b16 v[90:91], v8 offset:40320
v_mul_f32 v123, v35, v35
v_fma_f32 v122, v122, v114, v113
v_fma_f32 v123, v123, v114, v113
v_mul_f32 v122, v122, v34
v_mul_f32 v123, v123, v35
v_exp_f32 v122, v122
v_mfma_f32_32x32x16_bf16 v[48:63], a[136:139], v[156:159], v[48:63]
buffer_load_dwordx4 v135, s[44:47], s78 offen offset:1024 lds
ds_read_b64_tr_b16 v[92:93], v8 offset:40704
v_exp_f32 v123, v123
v_fma_f32 v122, v122, v112, v112
v_fma_f32 v123, v123, v112, v112
v_mfma_f32_32x32x16_bf16 v[64:79], a[140:143], v[156:159], v[64:79]
ds_read_b64_tr_b16 v[94:95], v8 offset:40832
buffer_load_dwordx4 v136, s[44:47], s78 offen offset:2048 lds
v_rcp_f32 v122, v122
v_rcp_f32 v123, v123
v_mul_f32 v122, v122, v34
v_mul_f32 v123, v123, v35
v_mfma_f32_32x32x16_bf16 v[48:63], a[144:147], v[160:163], v[48:63]
ds_read_b64_tr_b16 v[152:153], v8 offset:41216
v_cvt_pk_bf16_f32 v127, v122, v123
v_mul_f32 v120, v36, v36
v_mul_f32 v121, v37, v37
v_fma_f32 v120, v120, v114, v113
v_fma_f32 v121, v121, v114, v113
v_mfma_f32_32x32x16_bf16 v[64:79], a[148:151], v[160:163], v[64:79]
ds_read_b64_tr_b16 v[154:155], v8 offset:41344
ds_read_b128 a[112:115], v13 offset:25088
buffer_load_dwordx4 v137, s[44:47], s78 offen offset:3072 lds
v_mul_f32 v120, v120, v36
v_mul_f32 v121, v121, v37
v_exp_f32 v120, v120
v_exp_f32 v121, v121
v_mfma_f32_32x32x16_bf16 v[48:63], a[152:155], v[164:167], v[48:63]
ds_read_b64_tr_b16 v[156:157], v8 offset:41728
s_add_u32 s78, s82, 204800
s_add_u32 m0, s83, 4096
v_fma_f32 v120, v120, v112, v112
v_fma_f32 v121, v121, v112, v112
v_rcp_f32 v120, v120
v_rcp_f32 v121, v121
v_mfma_f32_32x32x16_bf16 v[64:79], a[156:159], v[164:167], v[64:79]
buffer_load_dwordx4 v138, s[44:47], s78 offen offset:0 lds
ds_read_b64_tr_b16 v[158:159], v8 offset:41856
ds_read_b128 a[116:119], v13 offset:25344
v_mul_f32 v120, v120, v36
v_mul_f32 v121, v121, v37
v_cvt_pk_bf16_f32 v128, v120, v121
v_mul_f32 v122, v38, v38
v_mul_f32 v123, v39, v39
s_waitcnt lgkmcnt(6)
v_mfma_f32_32x32x16_bf16 v[48:63], a[160:163], v[80:83], v[48:63]
ds_read_b64_tr_b16 v[160:161], v8 offset:42240
v_fma_f32 v122, v122, v114, v113
v_fma_f32 v123, v123, v114, v113
v_mul_f32 v122, v122, v38
v_mul_f32 v123, v123, v39
v_exp_f32 v122, v122
v_mfma_f32_32x32x16_bf16 v[64:79], a[164:167], v[80:83], v[64:79]
buffer_load_dwordx4 v139, s[44:47], s78 offen offset:1024 lds
ds_read_b64_tr_b16 v[162:163], v8 offset:42368
ds_read_b128 a[120:123], v13 offset:29184
v_exp_f32 v123, v123
v_fma_f32 v122, v122, v112, v112
v_fma_f32 v123, v123, v112, v112
v_rcp_f32 v122, v122
v_mfma_f32_32x32x16_bf16 v[48:63], a[168:171], v[84:87], v[48:63]
ds_read_b64_tr_b16 v[164:165], v8 offset:42752
buffer_load_dwordx4 v140, s[44:47], s78 offen offset:2048 lds
v_rcp_f32 v123, v123
v_mul_f32 v122, v122, v38
v_mul_f32 v123, v123, v39
v_cvt_pk_bf16_f32 v129, v122, v123
v_mfma_f32_32x32x16_bf16 v[64:79], a[172:175], v[84:87], v[64:79]
ds_read_b64_tr_b16 v[166:167], v8 offset:42880
ds_read_b128 a[124:127], v13 offset:29440
ds_write_b128 v12, v[126:129] offset:27136
v_mul_f32 v120, v40, v40
v_mul_f32 v121, v41, v41
v_fma_f32 v120, v120, v114, v113
v_fma_f32 v121, v121, v114, v113
v_mul_f32 v120, v120, v40
v_mfma_f32_32x32x16_bf16 v[48:63], a[176:179], v[88:91], v[48:63]
v_mul_f32 v121, v121, v41
v_exp_f32 v120, v120
v_exp_f32 v121, v121
v_mfma_f32_32x32x16_bf16 v[64:79], a[180:183], v[88:91], v[64:79]
ds_read_b128 a[128:131], v13 offset:33280
v_fma_f32 v120, v120, v112, v112
v_fma_f32 v121, v121, v112, v112
v_rcp_f32 v120, v120
v_rcp_f32 v121, v121
v_mfma_f32_32x32x16_bf16 v[48:63], a[184:187], v[92:95], v[48:63]
v_mul_f32 v120, v120, v40
v_mul_f32 v121, v121, v41
v_cvt_pk_bf16_f32 v130, v120, v121
v_mul_f32 v122, v42, v42
v_mul_f32 v123, v43, v43
v_mfma_f32_32x32x16_bf16 v[64:79], a[188:191], v[92:95], v[64:79]
ds_read_b128 a[132:135], v13 offset:33536
v_fma_f32 v122, v122, v114, v113
v_fma_f32 v123, v123, v114, v113
v_mul_f32 v122, v122, v42
v_mul_f32 v123, v123, v43
v_exp_f32 v122, v122
s_waitcnt lgkmcnt(4)
v_mfma_f32_32x32x16_bf16 v[48:63], a[192:195], v[152:155], v[48:63]
v_exp_f32 v123, v123
v_fma_f32 v122, v122, v112, v112
v_fma_f32 v123, v123, v112, v112
v_rcp_f32 v122, v122
v_mfma_f32_32x32x16_bf16 v[64:79], a[196:199], v[152:155], v[64:79]
ds_read_b128 a[136:139], v13 offset:37376
v_rcp_f32 v123, v123
v_mul_f32 v122, v122, v42
v_mul_f32 v123, v123, v43
v_cvt_pk_bf16_f32 v131, v122, v123
v_mfma_f32_32x32x16_bf16 v[48:63], a[200:203], v[156:159], v[48:63]
v_mul_f32 v120, v44, v44
v_mul_f32 v121, v45, v45
v_fma_f32 v120, v120, v114, v113
v_fma_f32 v121, v121, v114, v113
v_mul_f32 v120, v120, v44
v_mul_f32 v121, v121, v45
v_mfma_f32_32x32x16_bf16 v[64:79], a[204:207], v[156:159], v[64:79]
ds_read_b128 a[140:143], v13 offset:37632
v_exp_f32 v120, v120
v_exp_f32 v121, v121
v_fma_f32 v120, v120, v112, v112
v_mfma_f32_32x32x16_bf16 v[48:63], a[208:211], v[160:163], v[48:63]
v_fma_f32 v121, v121, v112, v112
v_rcp_f32 v120, v120
v_rcp_f32 v121, v121
v_mul_f32 v120, v120, v44
v_mfma_f32_32x32x16_bf16 v[64:79], a[212:215], v[160:163], v[64:79]
v_mul_f32 v121, v121, v45
v_cvt_pk_bf16_f32 v132, v120, v121
v_mul_f32 v122, v46, v46
v_mul_f32 v123, v47, v47
v_fma_f32 v122, v122, v114, v113
v_fma_f32 v123, v123, v114, v113
v_mfma_f32_32x32x16_bf16 v[48:63], a[216:219], v[164:167], v[48:63]
v_mul_f32 v122, v122, v46
v_mul_f32 v123, v123, v47
v_exp_f32 v122, v122
v_exp_f32 v123, v123
v_mfma_f32_32x32x16_bf16 v[64:79], a[220:223], v[164:167], v[64:79]
v_fma_f32 v122, v122, v112, v112
v_fma_f32 v123, v123, v112, v112
v_rcp_f32 v122, v122
v_rcp_f32 v123, v123
v_mfma_f32_32x32x16_bf16 v[48:63], v[96:99], v[108:111], v[48:63]
v_mul_f32 v122, v122, v46
v_mul_f32 v123, v123, v47
v_cvt_pk_bf16_f32 v133, v122, v123
v_mfma_f32_32x32x16_bf16 v[64:79], v[100:103], v[108:111], v[64:79]
ds_write_b128 v12, v[130:133] offset:28160
v_mfma_f32_16x16x32_bf16 v[152:155], a[224:227], a[112:115], 0
s_waitcnt vmcnt(0)
s_waitcnt lgkmcnt(0)
s_barrier
ds_read_b128 a[144:147], v13 offset:27136
v_mfma_f32_16x16x32_bf16 v[156:159], a[224:227], a[116:119], 0
ds_read_b128 a[148:151], v13 offset:27392
v_mfma_f32_16x16x32_bf16 v[152:155], v[200:203], a[120:123], v[152:155]
ds_read_b128 a[152:155], v13 offset:31232
v_mfma_f32_16x16x32_bf16 v[156:159], v[200:203], a[124:127], v[156:159]
ds_read_b128 a[156:159], v13 offset:31488
ds_read_b64_tr_b16 a[56:57], v6 offset:57344
v_mul_f32 v120, v48, v48
v_mul_f32 v121, v49, v49
v_fma_f32 v120, v120, v118, v117
v_fma_f32 v121, v121, v118, v117
v_mfma_f32_16x16x32_bf16 v[152:155], a[0:3], a[128:131], v[152:155]
ds_read_b64_tr_b16 a[58:59], v6 offset:64512
v_mul_f32 v120, v120, v48
v_mul_f32 v121, v121, v49
v_exp_f32 v120, v120
v_mfma_f32_16x16x32_bf16 v[156:159], a[0:3], a[132:135], v[156:159]
ds_read_b128 a[160:163], v13 offset:35328
ds_read_b128 a[164:167], v13 offset:35584
v_exp_f32 v121, v121
v_fma_f32 v120, v120, v116, v116
s_waitcnt lgkmcnt(7)
v_mfma_f32_16x16x32_bf16 v[152:155], v[172:175], a[144:147], v[152:155]
ds_read_b64_tr_b16 a[28:29], v6 offset:28672
ds_read_b64_tr_b16 a[30:31], v6 offset:35840
v_fma_f32 v121, v121, v116, v116
v_rcp_f32 v120, v120
v_rcp_f32 v121, v121
s_waitcnt lgkmcnt(8)
v_mfma_f32_16x16x32_bf16 v[156:159], v[172:175], a[148:151], v[156:159]
ds_read_b128 a[168:171], v13 offset:39424
ds_read_b128 a[172:175], v13 offset:39680
v_mul_f32 v120, v120, v48
v_mul_f32 v121, v121, v49
s_waitcnt lgkmcnt(9)
v_mfma_f32_16x16x32_bf16 v[152:155], v[228:231], a[152:155], v[152:155]
ds_read_b64_tr_b16 a[84:85], v6 offset:0
ds_read_b64_tr_b16 a[86:87], v6 offset:7168
v_cvt_pk_bf16_f32 v126, v120, v121
v_mul_f32 v122, v50, v50
v_mul_f32 v123, v51, v51
v_fma_f32 v122, v122, v118, v117
s_waitcnt lgkmcnt(10)
v_mfma_f32_16x16x32_bf16 v[156:159], v[228:231], a[156:159], v[156:159]
v_fma_f32 v123, v123, v118, v117
v_mul_f32 v122, v122, v50
v_mul_f32 v123, v123, v51
v_exp_f32 v122, v122
s_waitcnt lgkmcnt(8)
v_mfma_f32_16x16x32_bf16 v[152:155], a[56:59], a[136:139], v[152:155]
v_exp_f32 v123, v123
v_mfma_f32_16x16x32_bf16 v[156:159], a[56:59], a[140:143], v[156:159]
v_fma_f32 v122, v122, v116, v116
v_fma_f32 v123, v123, v116, v116
v_rcp_f32 v122, v122
s_waitcnt lgkmcnt(4)
v_mfma_f32_16x16x32_bf16 v[152:155], a[28:31], a[160:163], v[152:155]
v_rcp_f32 v123, v123
v_mul_f32 v122, v122, v50
v_mfma_f32_16x16x32_bf16 v[156:159], a[28:31], a[164:167], v[156:159]
ds_read_b64_tr_b16 a[32:33], v7 offset:28672
v_mul_f32 v123, v123, v51
v_cvt_pk_bf16_f32 v127, v122, v123
v_mul_f32 v120, v52, v52
v_mul_f32 v121, v53, v53
s_waitcnt lgkmcnt(1)
v_mfma_f32_16x16x32_bf16 v[152:155], a[84:87], a[168:171], v[152:155]
v_fma_f32 v120, v120, v118, v117
v_fma_f32 v121, v121, v118, v117
v_mul_f32 v120, v120, v52
v_mfma_f32_16x16x32_bf16 v[156:159], a[84:87], a[172:175], v[156:159]
ds_read_b64_tr_b16 a[34:35], v7 offset:35840
v_mul_f32 v121, v121, v53
v_exp_f32 v120, v120
v_exp_f32 v121, v121
v_mfma_f32_16x16x32_bf16 v[160:163], a[228:231], a[112:115], 0
v_fma_f32 v120, v120, v116, v116
v_fma_f32 v121, v121, v116, v116
v_rcp_f32 v120, v120
v_mfma_f32_16x16x32_bf16 v[164:167], a[228:231], a[116:119], 0
ds_read_b64_tr_b16 a[60:61], v7 offset:57344
v_rcp_f32 v121, v121
v_mfma_f32_16x16x32_bf16 v[160:163], v[204:207], a[120:123], v[160:163]
v_mul_f32 v120, v120, v52
v_mul_f32 v121, v121, v53
v_cvt_pk_bf16_f32 v128, v120, v121
v_mul_f32 v122, v54, v54
v_mfma_f32_16x16x32_bf16 v[164:167], v[204:207], a[124:127], v[164:167]
ds_read_b64_tr_b16 a[62:63], v7 offset:64512
v_cvt_pk_bf16_f32 v168, v152, v153
v_cvt_pk_bf16_f32 v169, v154, v155
v_mul_f32 v123, v55, v55
v_fma_f32 v122, v122, v118, v117
v_fma_f32 v123, v123, v118, v117
v_mfma_f32_16x16x32_bf16 v[160:163], a[4:7], a[128:131], v[160:163]
v_cvt_pk_bf16_f32 v170, v156, v157
v_mul_f32 v122, v122, v54
v_mul_f32 v123, v123, v55
v_exp_f32 v122, v122
v_mfma_f32_16x16x32_bf16 v[164:167], a[4:7], a[132:135], v[164:167]
ds_read_b64_tr_b16 a[88:89], v7 offset:0
v_cvt_pk_bf16_f32 v171, v158, v159
v_bfi_b32 v168, v11, s4, v168
v_exp_f32 v123, v123
v_fma_f32 v122, v122, v116, v116
v_fma_f32 v123, v123, v116, v116
v_mfma_f32_16x16x32_bf16 v[160:163], v[176:179], a[144:147], v[160:163]
v_bfi_b32 v169, v11, s5, v169
v_rcp_f32 v122, v122
v_rcp_f32 v123, v123
v_mfma_f32_16x16x32_bf16 v[164:167], v[176:179], a[148:151], v[164:167]
ds_read_b64_tr_b16 a[90:91], v7 offset:7168
v_bfi_b32 v170, v11, s6, v170
v_bfi_b32 v171, v11, s7, v171
v_mul_f32 v122, v122, v54
v_mul_f32 v123, v123, v55
v_cvt_pk_bf16_f32 v129, v122, v123
v_mfma_f32_16x16x32_bf16 v[160:163], v[232:235], a[152:155], v[160:163]
ds_write_b128 v12, v[126:129] offset:0
v_mul_f32 v120, v56, v56
v_mul_f32 v121, v57, v57
v_mfma_f32_16x16x32_bf16 v[164:167], v[232:235], a[156:159], v[164:167]
s_add_u32 s79, s73, 0
ds_read_b64_tr_b16 a[36:37], v141 offset:28672
buffer_store_dwordx4 v[168:171], v10, s[36:39], s79 offen offset:0 sc1
v_fma_f32 v120, v120, v118, v117
v_fma_f32 v121, v121, v118, v117
v_mul_f32 v120, v120, v56
v_mul_f32 v121, v121, v57
s_waitcnt lgkmcnt(4)
v_mfma_f32_16x16x32_bf16 v[160:163], a[60:63], a[136:139], v[160:163]
v_exp_f32 v120, v120
v_exp_f32 v121, v121
v_mfma_f32_16x16x32_bf16 v[164:167], a[60:63], a[140:143], v[164:167]
ds_read_b64_tr_b16 a[38:39], v141 offset:35840
v_fma_f32 v120, v120, v116, v116
v_fma_f32 v121, v121, v116, v116
v_rcp_f32 v120, v120
v_mfma_f32_16x16x32_bf16 v[160:163], a[32:35], a[160:163], v[160:163]
v_rcp_f32 v121, v121
v_mul_f32 v120, v120, v56
v_mfma_f32_16x16x32_bf16 v[164:167], a[32:35], a[164:167], v[164:167]
ds_read_b64_tr_b16 a[64:65], v141 offset:57344
v_mul_f32 v121, v121, v57
v_cvt_pk_bf16_f32 v130, v120, v121
v_mul_f32 v122, v58, v58
s_waitcnt lgkmcnt(4)
v_mfma_f32_16x16x32_bf16 v[160:163], a[88:91], a[168:171], v[160:163]
v_mul_f32 v123, v59, v59
v_fma_f32 v122, v122, v118, v117
v_fma_f32 v123, v123, v118, v117
v_mul_f32 v122, v122, v58
v_mfma_f32_16x16x32_bf16 v[164:167], a[88:91], a[172:175], v[164:167]
ds_read_b64_tr_b16 a[66:67], v141 offset:64512
v_mul_f32 v123, v123, v59
v_exp_f32 v122, v122
v_mfma_f32_16x16x32_bf16 v[152:155], a[232:235], a[112:115], 0
v_exp_f32 v123, v123
v_fma_f32 v122, v122, v116, v116
v_fma_f32 v123, v123, v116, v116
v_mfma_f32_16x16x32_bf16 v[156:159], a[232:235], a[116:119], 0
ds_read_b64_tr_b16 a[92:93], v141 offset:0
v_rcp_f32 v122, v122
v_rcp_f32 v123, v123
v_mfma_f32_16x16x32_bf16 v[152:155], v[180:183], a[144:147], v[152:155]
v_mul_f32 v122, v122, v58
v_mul_f32 v123, v123, v59
v_cvt_pk_bf16_f32 v131, v122, v123
v_mfma_f32_16x16x32_bf16 v[156:159], v[180:183], a[148:151], v[156:159]
ds_read_b64_tr_b16 a[94:95], v141 offset:7168
v_cvt_pk_bf16_f32 v168, v160, v161
v_cvt_pk_bf16_f32 v169, v162, v163
v_mul_f32 v120, v60, v60
v_mul_f32 v121, v61, v61
v_fma_f32 v120, v120, v118, v117
v_fma_f32 v121, v121, v118, v117
v_mfma_f32_16x16x32_bf16 v[152:155], v[208:211], a[120:123], v[152:155]
v_cvt_pk_bf16_f32 v170, v164, v165
v_mul_f32 v120, v120, v60
v_mul_f32 v121, v121, v61
v_exp_f32 v120, v120
v_mfma_f32_16x16x32_bf16 v[156:159], v[208:211], a[124:127], v[156:159]
ds_read_b64_tr_b16 a[40:41], v0 offset:28672
v_cvt_pk_bf16_f32 v171, v166, v167
v_bfi_b32 v168, v11, s4, v168
v_exp_f32 v121, v121
v_fma_f32 v120, v120, v116, v116
v_mfma_f32_16x16x32_bf16 v[152:155], v[236:239], a[152:155], v[152:155]
v_bfi_b32 v169, v11, s5, v169
v_fma_f32 v121, v121, v116, v116
v_rcp_f32 v120, v120
v_mfma_f32_16x16x32_bf16 v[156:159], v[236:239], a[156:159], v[156:159]
ds_read_b64_tr_b16 a[42:43], v0 offset:35840
v_bfi_b32 v170, v11, s6, v170
v_bfi_b32 v171, v11, s7, v171
v_rcp_f32 v121, v121
v_mul_f32 v120, v120, v60
v_mul_f32 v121, v121, v61
v_mfma_f32_16x16x32_bf16 v[152:155], a[8:11], a[128:131], v[152:155]
s_add_u32 s79, s73, 2048
v_cvt_pk_bf16_f32 v132, v120, v121
v_mul_f32 v122, v62, v62
v_mul_f32 v123, v63, v63
v_fma_f32 v122, v122, v118, v117
v_mfma_f32_16x16x32_bf16 v[156:159], a[8:11], a[132:135], v[156:159]
buffer_store_dwordx4 v[168:171], v10, s[36:39], s79 offen offset:0 sc1
ds_read_b64_tr_b16 a[68:69], v0 offset:57344
v_fma_f32 v123, v123, v118, v117
v_mul_f32 v122, v122, v62
v_mul_f32 v123, v123, v63
s_waitcnt lgkmcnt(7)
v_mfma_f32_16x16x32_bf16 v[152:155], a[36:39], a[160:163], v[152:155]
v_exp_f32 v122, v122
v_exp_f32 v123, v123
v_mfma_f32_16x16x32_bf16 v[156:159], a[36:39], a[164:167], v[156:159]
ds_read_b64_tr_b16 a[70:71], v0 offset:64512
v_fma_f32 v122, v122, v116, v116
v_fma_f32 v123, v123, v116, v116
v_rcp_f32 v122, v122
s_waitcnt lgkmcnt(6)
v_mfma_f32_16x16x32_bf16 v[152:155], a[64:67], a[136:139], v[152:155]
v_rcp_f32 v123, v123
v_mul_f32 v122, v122, v62
v_mfma_f32_16x16x32_bf16 v[156:159], a[64:67], a[140:143], v[156:159]
ds_read_b64_tr_b16 a[96:97], v0 offset:0
v_mul_f32 v123, v123, v63
v_cvt_pk_bf16_f32 v133, v122, v123
s_waitcnt lgkmcnt(5)
v_mfma_f32_16x16x32_bf16 v[152:155], a[92:95], a[168:171], v[152:155]
ds_write_b128 v12, v[130:133] offset:1024
v_mul_f32 v120, v64, v64
v_mul_f32 v121, v65, v65
v_fma_f32 v120, v120, v118, v117
v_fma_f32 v121, v121, v118, v117
v_mfma_f32_16x16x32_bf16 v[156:159], a[92:95], a[172:175], v[156:159]
ds_read_b64_tr_b16 a[98:99], v0 offset:7168
v_mul_f32 v120, v120, v64
v_mul_f32 v121, v121, v65
v_exp_f32 v120, v120
v_mfma_f32_16x16x32_bf16 v[160:163], a[236:239], a[112:115], 0
v_exp_f32 v121, v121
v_fma_f32 v120, v120, v116, v116
v_mfma_f32_16x16x32_bf16 v[164:167], a[236:239], a[116:119], 0
ds_read_b64_tr_b16 a[44:45], v4 offset:28672
v_fma_f32 v121, v121, v116, v116
v_rcp_f32 v120, v120
v_rcp_f32 v121, v121
v_mfma_f32_16x16x32_bf16 v[160:163], v[184:187], a[144:147], v[160:163]
v_mul_f32 v120, v120, v64
v_mul_f32 v121, v121, v65
v_mfma_f32_16x16x32_bf16 v[164:167], v[184:187], a[148:151], v[164:167]
ds_read_b64_tr_b16 a[46:47], v4 offset:35840
v_cvt_pk_bf16_f32 v168, v152, v153
v_cvt_pk_bf16_f32 v169, v154, v155
v_cvt_pk_bf16_f32 v126, v120, v121
v_mul_f32 v122, v66, v66
v_mul_f32 v123, v67, v67
v_fma_f32 v122, v122, v118, v117
v_mfma_f32_16x16x32_bf16 v[160:163], v[212:215], a[120:123], v[160:163]
v_cvt_pk_bf16_f32 v170, v156, v157
v_fma_f32 v123, v123, v118, v117
v_mul_f32 v122, v122, v66
v_mul_f32 v123, v123, v67
v_exp_f32 v122, v122
v_mfma_f32_16x16x32_bf16 v[164:167], v[212:215], a[124:127], v[164:167]
ds_read_b64_tr_b16 a[72:73], v4 offset:57344
v_cvt_pk_bf16_f32 v171, v158, v159
v_bfi_b32 v168, v11, s4, v168
v_exp_f32 v123, v123
v_mfma_f32_16x16x32_bf16 v[160:163], v[240:243], a[152:155], v[160:163]
v_bfi_b32 v169, v11, s5, v169
v_fma_f32 v122, v122, v116, v116
v_fma_f32 v123, v123, v116, v116
v_rcp_f32 v122, v122
v_mfma_f32_16x16x32_bf16 v[164:167], v[240:243], a[156:159], v[164:167]
ds_read_b64_tr_b16 a[74:75], v4 offset:64512
v_bfi_b32 v170, v11, s6, v170
v_bfi_b32 v171, v11, s7, v171
v_rcp_f32 v123, v123
v_mul_f32 v122, v122, v66
v_mfma_f32_16x16x32_bf16 v[160:163], a[12:15], a[128:131], v[160:163]
s_add_u32 s79, s73, 4096
v_mul_f32 v123, v123, v67
v_cvt_pk_bf16_f32 v127, v122, v123
v_mul_f32 v120, v68, v68
v_mul_f32 v121, v69, v69
v_mfma_f32_16x16x32_bf16 v[164:167], a[12:15], a[132:135], v[164:167]
buffer_store_dwordx4 v[168:171], v10, s[36:39], s79 offen offset:0 sc1
v_fma_f32 v120, v120, v118, v117
v_fma_f32 v121, v121, v118, v117
v_mul_f32 v120, v120, v68
s_waitcnt lgkmcnt(9)
v_mfma_f32_16x16x32_bf16 v[160:163], a[40:43], a[160:163], v[160:163]
ds_read_b64_tr_b16 a[100:101], v4 offset:0
v_mul_f32 v121, v121, v69
v_exp_f32 v120, v120
v_exp_f32 v121, v121
v_mfma_f32_16x16x32_bf16 v[164:167], a[40:43], a[164:167], v[164:167]
ds_read_b64_tr_b16 a[102:103], v4 offset:7168
v_fma_f32 v120, v120, v116, v116
v_fma_f32 v121, v121, v116, v116
v_rcp_f32 v120, v120
s_waitcnt lgkmcnt(9)
v_mfma_f32_16x16x32_bf16 v[160:163], a[68:71], a[136:139], v[160:163]
v_rcp_f32 v121, v121
v_mfma_f32_16x16x32_bf16 v[164:167], a[68:71], a[140:143], v[164:167]
ds_read_b64_tr_b16 a[48:49], v5 offset:28672
v_mul_f32 v120, v120, v68
v_mul_f32 v121, v121, v69
v_cvt_pk_bf16_f32 v128, v120, v121
v_mul_f32 v122, v70, v70
s_waitcnt lgkmcnt(7)
v_mfma_f32_16x16x32_bf16 v[160:163], a[96:99], a[168:171], v[160:163]
v_mul_f32 v123, v71, v71
v_fma_f32 v122, v122, v118, v117
v_fma_f32 v123, v123, v118, v117
v_mfma_f32_16x16x32_bf16 v[164:167], a[96:99], a[172:175], v[164:167]
ds_read_b64_tr_b16 a[50:51], v5 offset:35840
v_mul_f32 v122, v122, v70
v_mul_f32 v123, v123, v71
v_exp_f32 v122, v122
v_mfma_f32_16x16x32_bf16 v[152:155], a[240:243], a[112:115], 0
v_exp_f32 v123, v123
v_fma_f32 v122, v122, v116, v116
v_fma_f32 v123, v123, v116, v116
v_mfma_f32_16x16x32_bf16 v[156:159], a[240:243], a[116:119], 0
ds_read_b64_tr_b16 a[76:77], v5 offset:57344
v_rcp_f32 v122, v122
v_rcp_f32 v123, v123
v_mfma_f32_16x16x32_bf16 v[152:155], v[188:191], a[144:147], v[152:155]
v_mul_f32 v122, v122, v70
v_mul_f32 v123, v123, v71
v_cvt_pk_bf16_f32 v129, v122, v123
v_mfma_f32_16x16x32_bf16 v[156:159], v[188:191], a[148:151], v[156:159]
ds_write_b128 v12, v[126:129] offset:2048
v_cvt_pk_bf16_f32 v168, v160, v161
v_cvt_pk_bf16_f32 v169, v162, v163
v_mul_f32 v120, v72, v72
v_mul_f32 v121, v73, v73
v_mfma_f32_16x16x32_bf16 v[152:155], v[216:219], a[120:123], v[152:155]
ds_read_b64_tr_b16 a[78:79], v5 offset:64512
v_cvt_pk_bf16_f32 v170, v164, v165
v_fma_f32 v120, v120, v118, v117
v_fma_f32 v121, v121, v118, v117
v_mul_f32 v120, v120, v72
v_mul_f32 v121, v121, v73
v_mfma_f32_16x16x32_bf16 v[156:159], v[216:219], a[124:127], v[156:159]
ds_read_b64_tr_b16 a[104:105], v5 offset:0
v_cvt_pk_bf16_f32 v171, v166, v167
v_bfi_b32 v168, v11, s4, v168
v_exp_f32 v120, v120
v_exp_f32 v121, v121
v_mfma_f32_16x16x32_bf16 v[152:155], v[244:247], a[152:155], v[152:155]
v_bfi_b32 v169, v11, s5, v169
v_fma_f32 v120, v120, v116, v116
v_fma_f32 v121, v121, v116, v116
v_rcp_f32 v120, v120
v_mfma_f32_16x16x32_bf16 v[156:159], v[244:247], a[156:159], v[156:159]
ds_read_b64_tr_b16 a[106:107], v5 offset:7168
v_bfi_b32 v170, v11, s6, v170
v_bfi_b32 v171, v11, s7, v171
v_rcp_f32 v121, v121
v_mul_f32 v120, v120, v72
v_mfma_f32_16x16x32_bf16 v[152:155], a[16:19], a[128:131], v[152:155]
s_add_u32 s79, s73, 6144
v_mul_f32 v121, v121, v73
v_cvt_pk_bf16_f32 v130, v120, v121
v_mul_f32 v122, v74, v74
v_mfma_f32_16x16x32_bf16 v[156:159], a[16:19], a[132:135], v[156:159]
buffer_store_dwordx4 v[168:171], v10, s[36:39], s79 offen offset:0 sc1
v_mul_f32 v123, v75, v75
v_fma_f32 v122, v122, v118, v117
v_fma_f32 v123, v123, v118, v117
v_mul_f32 v122, v122, v74
s_waitcnt lgkmcnt(11)
v_mfma_f32_16x16x32_bf16 v[152:155], a[44:47], a[160:163], v[152:155]
ds_read_b64_tr_b16 a[52:53], v9 offset:28672
v_mul_f32 v123, v123, v75
v_exp_f32 v122, v122
v_mfma_f32_16x16x32_bf16 v[156:159], a[44:47], a[164:167], v[156:159]
ds_read_b64_tr_b16 a[54:55], v9 offset:35840
v_exp_f32 v123, v123
v_fma_f32 v122, v122, v116, v116
v_fma_f32 v123, v123, v116, v116
s_waitcnt lgkmcnt(11)
v_mfma_f32_16x16x32_bf16 v[152:155], a[72:75], a[136:139], v[152:155]
v_rcp_f32 v122, v122
v_rcp_f32 v123, v123
v_mfma_f32_16x16x32_bf16 v[156:159], a[72:75], a[140:143], v[156:159]
ds_read_b64_tr_b16 a[80:81], v9 offset:57344
v_mul_f32 v122, v122, v74
v_mul_f32 v123, v123, v75
v_cvt_pk_bf16_f32 v131, v122, v123
s_waitcnt lgkmcnt(10)
v_mfma_f32_16x16x32_bf16 v[152:155], a[100:103], a[168:171], v[152:155]
v_mul_f32 v120, v76, v76
v_mul_f32 v121, v77, v77
v_fma_f32 v120, v120, v118, v117
v_fma_f32 v121, v121, v118, v117
v_mfma_f32_16x16x32_bf16 v[156:159], a[100:103], a[172:175], v[156:159]
ds_read_b64_tr_b16 a[82:83], v9 offset:64512
v_mul_f32 v120, v120, v76
v_mul_f32 v121, v121, v77
v_exp_f32 v120, v120
v_mfma_f32_16x16x32_bf16 v[160:163], a[244:247], a[112:115], 0
v_exp_f32 v121, v121
v_fma_f32 v120, v120, v116, v116
v_mfma_f32_16x16x32_bf16 v[164:167], a[244:247], a[116:119], 0
ds_read_b64_tr_b16 a[108:109], v9 offset:0
v_fma_f32 v121, v121, v116, v116
v_rcp_f32 v120, v120
v_mfma_f32_16x16x32_bf16 v[160:163], v[192:195], a[144:147], v[160:163]
v_rcp_f32 v121, v121
v_mul_f32 v120, v120, v76
v_mul_f32 v121, v121, v77
v_mfma_f32_16x16x32_bf16 v[164:167], v[192:195], a[148:151], v[164:167]
ds_read_b64_tr_b16 a[110:111], v9 offset:7168
v_cvt_pk_bf16_f32 v168, v152, v153
v_cvt_pk_bf16_f32 v169, v154, v155
v_cvt_pk_bf16_f32 v132, v120, v121
v_mul_f32 v122, v78, v78
v_mul_f32 v123, v79, v79
v_fma_f32 v122, v122, v118, v117
v_mfma_f32_16x16x32_bf16 v[160:163], v[220:223], a[120:123], v[160:163]
v_cvt_pk_bf16_f32 v170, v156, v157
v_fma_f32 v123, v123, v118, v117
v_mul_f32 v122, v122, v78
v_mul_f32 v123, v123, v79
v_mfma_f32_16x16x32_bf16 v[164:167], v[220:223], a[124:127], v[164:167]
v_cvt_pk_bf16_f32 v171, v158, v159
v_bfi_b32 v168, v11, s4, v168
v_exp_f32 v122, v122
v_exp_f32 v123, v123
v_mfma_f32_16x16x32_bf16 v[160:163], v[248:251], a[152:155], v[160:163]
v_bfi_b32 v169, v11, s5, v169
v_fma_f32 v122, v122, v116, v116
v_fma_f32 v123, v123, v116, v116
v_rcp_f32 v122, v122
v_mfma_f32_16x16x32_bf16 v[164:167], v[248:251], a[156:159], v[164:167]
v_bfi_b32 v170, v11, s6, v170
v_bfi_b32 v171, v11, s7, v171
v_rcp_f32 v123, v123
v_mul_f32 v122, v122, v78
v_mfma_f32_16x16x32_bf16 v[160:163], a[20:23], a[128:131], v[160:163]
s_add_u32 s79, s73, 8192
v_mul_f32 v123, v123, v79
v_cvt_pk_bf16_f32 v133, v122, v123
v_mfma_f32_16x16x32_bf16 v[164:167], a[20:23], a[132:135], v[164:167]
ds_write_b128 v12, v[130:133] offset:3072
buffer_store_dwordx4 v[168:171], v10, s[36:39], s79 offen offset:0 sc1
s_waitcnt lgkmcnt(12)
v_mfma_f32_16x16x32_bf16 v[160:163], a[48:51], a[160:163], v[160:163]
v_mfma_f32_16x16x32_bf16 v[164:167], a[48:51], a[164:167], v[164:167]
s_waitcnt lgkmcnt(0)
s_barrier
ds_read_b128 a[176:179], v13 offset:0
v_mfma_f32_16x16x32_bf16 v[160:163], a[76:79], a[136:139], v[160:163]
v_mfma_f32_16x16x32_bf16 v[164:167], a[76:79], a[140:143], v[164:167]
ds_read_b128 a[180:183], v13 offset:256
v_mfma_f32_16x16x32_bf16 v[160:163], a[104:107], a[168:171], v[160:163]
ds_read_b128 a[184:187], v13 offset:2048
v_mfma_f32_16x16x32_bf16 v[164:167], a[104:107], a[172:175], v[164:167]
ds_read_b128 a[188:191], v13 offset:2304
s_waitcnt lgkmcnt(3)
v_mfma_f32_16x16x32_bf16 v[152:155], a[224:227], a[176:179], 0
ds_read_b128 a[192:195], v13 offset:4096
s_waitcnt lgkmcnt(3)
v_mfma_f32_16x16x32_bf16 v[156:159], a[224:227], a[180:183], 0
ds_read_b128 a[196:199], v13 offset:4352
s_waitcnt lgkmcnt(3)
v_mfma_f32_16x16x32_bf16 v[152:155], v[172:175], a[184:187], v[152:155]
ds_read_b128 a[200:203], v13 offset:6144
s_waitcnt lgkmcnt(3)
v_mfma_f32_16x16x32_bf16 v[156:159], v[172:175], a[188:191], v[156:159]
ds_read_b128 a[204:207], v13 offset:6400
v_cvt_pk_bf16_f32 v168, v160, v161
v_cvt_pk_bf16_f32 v169, v162, v163
s_waitcnt lgkmcnt(3)
v_mfma_f32_16x16x32_bf16 v[152:155], v[200:203], a[192:195], v[152:155]
ds_read_b128 a[208:211], v13 offset:8192
v_cvt_pk_bf16_f32 v170, v164, v165
s_waitcnt lgkmcnt(3)
v_mfma_f32_16x16x32_bf16 v[156:159], v[200:203], a[196:199], v[156:159]
ds_read_b128 a[212:215], v13 offset:8448
v_cvt_pk_bf16_f32 v171, v166, v167
v_bfi_b32 v168, v11, s4, v168
s_waitcnt lgkmcnt(3)
v_mfma_f32_16x16x32_bf16 v[152:155], v[228:231], a[200:203], v[152:155]
ds_read_b128 a[216:219], v13 offset:10240
v_bfi_b32 v169, v11, s5, v169
s_waitcnt lgkmcnt(3)
v_mfma_f32_16x16x32_bf16 v[156:159], v[228:231], a[204:207], v[156:159]
ds_read_b128 a[220:223], v13 offset:10496
ds_read_b128 v[80:83], v13 offset:12288
v_bfi_b32 v170, v11, s6, v170
v_bfi_b32 v171, v11, s7, v171
s_waitcnt lgkmcnt(4)
v_mfma_f32_16x16x32_bf16 v[152:155], a[0:3], a[208:211], v[152:155]
ds_read_b128 v[84:87], v13 offset:12544
s_waitcnt lgkmcnt(4)
v_mfma_f32_16x16x32_bf16 v[156:159], a[0:3], a[212:215], v[156:159]
s_add_u32 s79, s73, 10240
ds_read_b128 v[88:91], v13 offset:14336
buffer_store_dwordx4 v[168:171], v10, s[36:39], s79 offen offset:0 sc1
s_waitcnt lgkmcnt(4)
v_mfma_f32_16x16x32_bf16 v[152:155], a[28:31], a[216:219], v[152:155]
ds_read_b128 v[92:95], v13 offset:14592
v_lshlrev_b32 v120, 16, v150
s_waitcnt lgkmcnt(4)
v_mfma_f32_16x16x32_bf16 v[156:159], a[28:31], a[220:223], v[156:159]
s_waitcnt lgkmcnt(3)
v_mfma_f32_16x16x32_bf16 v[152:155], a[56:59], v[80:83], v[152:155]
v_and_b32 v121, s65, v150
s_waitcnt lgkmcnt(2)
v_mfma_f32_16x16x32_bf16 v[156:159], a[56:59], v[84:87], v[156:159]
s_waitcnt lgkmcnt(1)
v_mfma_f32_16x16x32_bf16 v[152:155], a[84:87], v[88:91], v[152:155]
s_waitcnt lgkmcnt(0)
v_mfma_f32_16x16x32_bf16 v[156:159], a[84:87], v[92:95], v[156:159]
v_lshlrev_b32 v122, 16, v151
v_mfma_f32_16x16x32_bf16 v[160:163], a[228:231], a[176:179], 0
v_mfma_f32_16x16x32_bf16 v[164:167], a[228:231], a[180:183], 0
v_and_b32 v123, s65, v151
v_mfma_f32_16x16x32_bf16 v[160:163], v[176:179], a[184:187], v[160:163]
v_mfma_f32_16x16x32_bf16 v[164:167], v[176:179], a[188:191], v[164:167]
v_cvt_pk_bf16_f32 v168, v152, v153
v_cvt_pk_bf16_f32 v169, v154, v155
v_mfma_f32_16x16x32_bf16 v[160:163], v[204:207], a[192:195], v[160:163]
v_cvt_pk_bf16_f32 v170, v156, v157
v_lshlrev_b32 v64, 16, v142
v_mfma_f32_16x16x32_bf16 v[164:167], v[204:207], a[196:199], v[164:167]
v_cvt_pk_bf16_f32 v171, v158, v159
v_bfi_b32 v168, v11, s4, v168
v_mfma_f32_16x16x32_bf16 v[160:163], v[232:235], a[200:203], v[160:163]
v_bfi_b32 v169, v11, s5, v169
v_and_b32 v65, s65, v142
v_mfma_f32_16x16x32_bf16 v[164:167], v[232:235], a[204:207], v[164:167]
v_bfi_b32 v170, v11, s6, v170
v_bfi_b32 v171, v11, s7, v171
v_mfma_f32_16x16x32_bf16 v[160:163], a[4:7], a[208:211], v[160:163]
buffer_load_dwordx4 v[16:19], v10, s[36:39], s92 offen offset:0 sc1
v_mfma_f32_16x16x32_bf16 v[164:167], a[4:7], a[212:215], v[164:167]
s_add_u32 s79, s73, 0
buffer_store_dwordx4 v[168:171], v10, s[36:39], s79 offen offset:1024 sc1
v_add_f32 v64, v64, v120
v_mfma_f32_16x16x32_bf16 v[160:163], a[32:35], a[216:219], v[160:163]
v_mfma_f32_16x16x32_bf16 v[164:167], a[32:35], a[220:223], v[164:167]
v_add_f32 v65, v65, v121
v_mfma_f32_16x16x32_bf16 v[160:163], a[60:63], v[80:83], v[160:163]
v_mfma_f32_16x16x32_bf16 v[164:167], a[60:63], v[84:87], v[164:167]
v_mfma_f32_16x16x32_bf16 v[160:163], a[88:91], v[88:91], v[160:163]
v_lshlrev_b32 v66, 16, v143
v_mfma_f32_16x16x32_bf16 v[164:167], a[88:91], v[92:95], v[164:167]
v_mfma_f32_16x16x32_bf16 v[152:155], a[232:235], a[176:179], 0
v_and_b32 v67, s65, v143
v_mfma_f32_16x16x32_bf16 v[156:159], a[232:235], a[180:183], 0
v_mfma_f32_16x16x32_bf16 v[152:155], v[180:183], a[184:187], v[152:155]
v_mfma_f32_16x16x32_bf16 v[156:159], v[180:183], a[188:191], v[156:159]
s_nop 0
v_cvt_pk_bf16_f32 v168, v160, v161
v_cvt_pk_bf16_f32 v169, v162, v163
v_add_f32 v66, v66, v122
v_mfma_f32_16x16x32_bf16 v[152:155], v[208:211], a[192:195], v[152:155]
v_cvt_pk_bf16_f32 v170, v164, v165
v_mfma_f32_16x16x32_bf16 v[156:159], v[208:211], a[196:199], v[156:159]
v_cvt_pk_bf16_f32 v171, v166, v167
v_bfi_b32 v168, v11, s4, v168
v_add_f32 v67, v67, v123
v_mfma_f32_16x16x32_bf16 v[152:155], v[236:239], a[200:203], v[152:155]
v_bfi_b32 v169, v11, s5, v169
v_mfma_f32_16x16x32_bf16 v[156:159], v[236:239], a[204:207], v[156:159]
v_bfi_b32 v170, v11, s6, v170
v_bfi_b32 v171, v11, s7, v171
v_mfma_f32_16x16x32_bf16 v[152:155], a[8:11], a[208:211], v[152:155]
buffer_load_dwordx4 v[20:23], v10, s[36:39], s93 offen offset:0 sc1
v_lshlrev_b32 v68, 16, v144
v_mfma_f32_16x16x32_bf16 v[156:159], a[8:11], a[212:215], v[156:159]
s_add_u32 s79, s73, 2048
buffer_store_dwordx4 v[168:171], v10, s[36:39], s79 offen offset:1024 sc1
v_mfma_f32_16x16x32_bf16 v[152:155], a[36:39], a[216:219], v[152:155]
v_and_b32 v69, s65, v144
v_mfma_f32_16x16x32_bf16 v[156:159], a[36:39], a[220:223], v[156:159]
v_mfma_f32_16x16x32_bf16 v[152:155], a[64:67], v[80:83], v[152:155]
v_mfma_f32_16x16x32_bf16 v[156:159], a[64:67], v[84:87], v[156:159]
v_add_f32 v68, v68, v120
v_mfma_f32_16x16x32_bf16 v[152:155], a[92:95], v[88:91], v[152:155]
v_mfma_f32_16x16x32_bf16 v[156:159], a[92:95], v[92:95], v[156:159]
v_add_f32 v69, v69, v121
v_mfma_f32_16x16x32_bf16 v[160:163], a[236:239], a[176:179], 0
v_mfma_f32_16x16x32_bf16 v[164:167], a[236:239], a[180:183], 0
v_mfma_f32_16x16x32_bf16 v[160:163], v[184:187], a[184:187], v[160:163]
v_lshlrev_b32 v70, 16, v145
v_mfma_f32_16x16x32_bf16 v[164:167], v[184:187], a[188:191], v[164:167]
s_nop 0
v_cvt_pk_bf16_f32 v168, v152, v153
v_cvt_pk_bf16_f32 v169, v154, v155
v_mfma_f32_16x16x32_bf16 v[160:163], v[212:215], a[192:195], v[160:163]
v_cvt_pk_bf16_f32 v170, v156, v157
v_and_b32 v71, s65, v145
v_mfma_f32_16x16x32_bf16 v[164:167], v[212:215], a[196:199], v[164:167]
v_cvt_pk_bf16_f32 v171, v158, v159
v_bfi_b32 v168, v11, s4, v168
v_mfma_f32_16x16x32_bf16 v[160:163], v[240:243], a[200:203], v[160:163]
v_bfi_b32 v169, v11, s5, v169
v_mfma_f32_16x16x32_bf16 v[164:167], v[240:243], a[204:207], v[164:167]
v_bfi_b32 v170, v11, s6, v170
v_bfi_b32 v171, v11, s7, v171
v_add_f32 v70, v70, v122
v_mfma_f32_16x16x32_bf16 v[160:163], a[12:15], a[208:211], v[160:163]
buffer_load_dwordx4 v[24:27], v10, s[36:39], s94 offen offset:0 sc1
v_mfma_f32_16x16x32_bf16 v[164:167], a[12:15], a[212:215], v[164:167]
s_add_u32 s79, s73, 4096
buffer_store_dwordx4 v[168:171], v10, s[36:39], s79 offen offset:1024 sc1
v_add_f32 v71, v71, v123
v_mfma_f32_16x16x32_bf16 v[160:163], a[40:43], a[216:219], v[160:163]
v_mfma_f32_16x16x32_bf16 v[164:167], a[40:43], a[220:223], v[164:167]
v_mfma_f32_16x16x32_bf16 v[160:163], a[68:71], v[80:83], v[160:163]
v_lshlrev_b32 v72, 16, v146
v_mfma_f32_16x16x32_bf16 v[164:167], a[68:71], v[84:87], v[164:167]
v_mfma_f32_16x16x32_bf16 v[160:163], a[96:99], v[88:91], v[160:163]
v_and_b32 v73, s65, v146
v_mfma_f32_16x16x32_bf16 v[164:167], a[96:99], v[92:95], v[164:167]
v_mfma_f32_16x16x32_bf16 v[152:155], a[240:243], a[176:179], 0
v_mfma_f32_16x16x32_bf16 v[156:159], a[240:243], a[180:183], 0
v_add_f32 v72, v72, v120
v_mfma_f32_16x16x32_bf16 v[152:155], v[188:191], a[184:187], v[152:155]
v_mfma_f32_16x16x32_bf16 v[156:159], v[188:191], a[188:191], v[156:159]
s_nop 0
v_cvt_pk_bf16_f32 v168, v160, v161
v_cvt_pk_bf16_f32 v169, v162, v163
v_add_f32 v73, v73, v121
v_mfma_f32_16x16x32_bf16 v[152:155], v[216:219], a[192:195], v[152:155]
v_cvt_pk_bf16_f32 v170, v164, v165
v_mfma_f32_16x16x32_bf16 v[156:159], v[216:219], a[196:199], v[156:159]
v_cvt_pk_bf16_f32 v171, v166, v167
v_bfi_b32 v168, v11, s4, v168
v_mfma_f32_16x16x32_bf16 v[152:155], v[244:247], a[200:203], v[152:155]
v_bfi_b32 v169, v11, s5, v169
v_lshlrev_b32 v74, 16, v147
v_mfma_f32_16x16x32_bf16 v[156:159], v[244:247], a[204:207], v[156:159]
v_bfi_b32 v170, v11, s6, v170
v_bfi_b32 v171, v11, s7, v171
v_mfma_f32_16x16x32_bf16 v[152:155], a[16:19], a[208:211], v[152:155]
buffer_load_dwordx4 v[28:31], v10, s[36:39], s95 offen offset:0 sc1
v_and_b32 v75, s65, v147
v_mfma_f32_16x16x32_bf16 v[156:159], a[16:19], a[212:215], v[156:159]
s_add_u32 s79, s73, 6144
buffer_store_dwordx4 v[168:171], v10, s[36:39], s79 offen offset:1024 sc1
v_mfma_f32_16x16x32_bf16 v[152:155], a[44:47], a[216:219], v[152:155]
v_mfma_f32_16x16x32_bf16 v[156:159], a[44:47], a[220:223], v[156:159]
v_add_f32 v74, v74, v122
v_mfma_f32_16x16x32_bf16 v[152:155], a[72:75], v[80:83], v[152:155]
v_mfma_f32_16x16x32_bf16 v[156:159], a[72:75], v[84:87], v[156:159]
v_add_f32 v75, v75, v123
v_mfma_f32_16x16x32_bf16 v[152:155], a[100:103], v[88:91], v[152:155]
v_mfma_f32_16x16x32_bf16 v[156:159], a[100:103], v[92:95], v[156:159]
v_mfma_f32_16x16x32_bf16 v[160:163], a[244:247], a[176:179], 0
v_lshlrev_b32 v76, 16, v148
v_mfma_f32_16x16x32_bf16 v[164:167], a[244:247], a[180:183], 0
v_mfma_f32_16x16x32_bf16 v[160:163], v[192:195], a[184:187], v[160:163]
v_and_b32 v77, s65, v148
v_mfma_f32_16x16x32_bf16 v[164:167], v[192:195], a[188:191], v[164:167]
s_nop 0
v_cvt_pk_bf16_f32 v168, v152, v153
v_cvt_pk_bf16_f32 v169, v154, v155
v_mfma_f32_16x16x32_bf16 v[160:163], v[220:223], a[192:195], v[160:163]
v_cvt_pk_bf16_f32 v170, v156, v157
v_mfma_f32_16x16x32_bf16 v[164:167], v[220:223], a[196:199], v[164:167]
v_cvt_pk_bf16_f32 v171, v158, v159
v_bfi_b32 v168, v11, s4, v168
v_add_f32 v76, v76, v120
v_mfma_f32_16x16x32_bf16 v[160:163], v[248:251], a[200:203], v[160:163]
v_bfi_b32 v169, v11, s5, v169
v_mfma_f32_16x16x32_bf16 v[164:167], v[248:251], a[204:207], v[164:167]
v_bfi_b32 v170, v11, s6, v170
v_bfi_b32 v171, v11, s7, v171
v_add_f32 v77, v77, v121
v_mfma_f32_16x16x32_bf16 v[160:163], a[20:23], a[208:211], v[160:163]
buffer_load_dwordx4 v[32:35], v10, s[36:39], s96 offen offset:0 sc1
v_mfma_f32_16x16x32_bf16 v[164:167], a[20:23], a[212:215], v[164:167]
s_add_u32 s79, s73, 8192
buffer_store_dwordx4 v[168:171], v10, s[36:39], s79 offen offset:1024 sc1
v_mfma_f32_16x16x32_bf16 v[160:163], a[48:51], a[216:219], v[160:163]
v_lshlrev_b32 v78, 16, v149
v_mfma_f32_16x16x32_bf16 v[164:167], a[48:51], a[220:223], v[164:167]
v_mfma_f32_16x16x32_bf16 v[160:163], a[76:79], v[80:83], v[160:163]
v_and_b32 v79, s65, v149
v_mfma_f32_16x16x32_bf16 v[164:167], a[76:79], v[84:87], v[164:167]
v_mfma_f32_16x16x32_bf16 v[160:163], a[104:107], v[88:91], v[160:163]
v_mfma_f32_16x16x32_bf16 v[164:167], a[104:107], v[92:95], v[164:167]
v_add_f32 v78, v78, v122
v_mfma_f32_16x16x32_bf16 v[96:99], a[248:251], a[112:115], 0
v_mfma_f32_16x16x32_bf16 v[100:103], a[248:251], a[116:119], 0
v_add_f32 v79, v79, v123
v_mfma_f32_16x16x32_bf16 v[96:99], v[196:199], a[144:147], v[96:99]
v_mfma_f32_16x16x32_bf16 v[100:103], v[196:199], a[148:151], v[100:103]
s_nop 0
v_cvt_pk_bf16_f32 v168, v160, v161
v_cvt_pk_bf16_f32 v169, v162, v163
v_mfma_f32_16x16x32_bf16 v[96:99], v[224:227], a[120:123], v[96:99]
v_cvt_pk_bf16_f32 v170, v164, v165
v_mfma_f32_16x16x32_bf16 v[100:103], v[224:227], a[124:127], v[100:103]
v_cvt_pk_bf16_f32 v171, v166, v167
v_bfi_b32 v168, v11, s4, v168
v_mfma_f32_16x16x32_bf16 v[96:99], v[252:255], a[152:155], v[96:99]
v_bfi_b32 v169, v11, s5, v169
v_mfma_f32_16x16x32_bf16 v[100:103], v[252:255], a[156:159], v[100:103]
v_bfi_b32 v170, v11, s6, v170
v_bfi_b32 v171, v11, s7, v171
v_mfma_f32_16x16x32_bf16 v[96:99], a[24:27], a[128:131], v[96:99]
buffer_load_dwordx4 v[36:39], v10, s[36:39], s97 offen offset:0 sc1
v_mfma_f32_16x16x32_bf16 v[100:103], a[24:27], a[132:135], v[100:103]
s_add_u32 s79, s73, 10240
buffer_store_dwordx4 v[168:171], v10, s[36:39], s79 offen offset:1024 sc1
v_mfma_f32_16x16x32_bf16 v[96:99], a[52:55], a[160:163], v[96:99]
v_mfma_f32_16x16x32_bf16 v[100:103], a[52:55], a[164:167], v[100:103]
v_mfma_f32_16x16x32_bf16 v[96:99], a[80:83], a[136:139], v[96:99]
v_mfma_f32_16x16x32_bf16 v[100:103], a[80:83], a[140:143], v[100:103]
v_mfma_f32_16x16x32_bf16 v[96:99], a[108:111], a[168:171], v[96:99]
v_mfma_f32_16x16x32_bf16 v[100:103], a[108:111], a[172:175], v[100:103]
v_mfma_f32_16x16x32_bf16 v[104:107], a[248:251], a[176:179], 0
v_mfma_f32_16x16x32_bf16 v[108:111], a[248:251], a[180:183], 0
v_mfma_f32_16x16x32_bf16 v[104:107], v[196:199], a[184:187], v[104:107]
v_mfma_f32_16x16x32_bf16 v[108:111], v[196:199], a[188:191], v[108:111]
v_mfma_f32_16x16x32_bf16 v[104:107], v[224:227], a[192:195], v[104:107]
v_mfma_f32_16x16x32_bf16 v[108:111], v[224:227], a[196:199], v[108:111]
v_mfma_f32_16x16x32_bf16 v[104:107], v[252:255], a[200:203], v[104:107]
v_mfma_f32_16x16x32_bf16 v[108:111], v[252:255], a[204:207], v[108:111]
v_mfma_f32_16x16x32_bf16 v[104:107], a[24:27], a[208:211], v[104:107]
v_mfma_f32_16x16x32_bf16 v[108:111], a[24:27], a[212:215], v[108:111]
v_mfma_f32_16x16x32_bf16 v[104:107], a[52:55], a[216:219], v[104:107]
v_mfma_f32_16x16x32_bf16 v[108:111], a[52:55], a[220:223], v[108:111]
v_mfma_f32_16x16x32_bf16 v[104:107], a[80:83], v[80:83], v[104:107]
v_mfma_f32_16x16x32_bf16 v[108:111], a[80:83], v[84:87], v[108:111]
v_mfma_f32_16x16x32_bf16 v[104:107], a[108:111], v[88:91], v[104:107]
v_mfma_f32_16x16x32_bf16 v[108:111], a[108:111], v[92:95], v[108:111]
s_waitcnt vmcnt(0)
buffer_load_dwordx4 v[40:43], v10, s[36:39], s92 offen offset:1024 sc1
buffer_load_dwordx4 v[44:47], v10, s[36:39], s93 offen offset:1024 sc1
buffer_load_dwordx4 v[48:51], v10, s[36:39], s94 offen offset:1024 sc1
buffer_load_dwordx4 v[52:55], v10, s[36:39], s95 offen offset:1024 sc1
buffer_load_dwordx4 v[56:59], v10, s[36:39], s96 offen offset:1024 sc1
buffer_load_dwordx4 v[60:63], v10, s[36:39], s97 offen offset:1024 sc1
s_mov_b32 s68, 0
v_pk_add_f32 v[64:65], v[64:65], v[96:97]
v_pk_add_f32 v[66:67], v[66:67], v[98:99]
v_pk_add_f32 v[68:69], v[68:69], v[100:101]
v_pk_add_f32 v[70:71], v[70:71], v[102:103]
v_pk_add_f32 v[72:73], v[72:73], v[104:105]
v_pk_add_f32 v[74:75], v[74:75], v[106:107]
v_pk_add_f32 v[76:77], v[76:77], v[108:109]
v_pk_add_f32 v[78:79], v[78:79], v[110:111]
v_xor_b32 v16, s4, v16
v_xor_b32 v17, s5, v17
v_xor_b32 v18, s6, v18
v_xor_b32 v19, s7, v19
v_or3_b32 v141, v16, v17, 0
v_or3_b32 v141, v18, v19, v141
v_dot2_f32_bf16 v80, v16, s98, v64
v_dot2_f32_bf16 v81, v16, s99, v65
v_dot2_f32_bf16 v82, v17, s98, v66
v_dot2_f32_bf16 v83, v17, s99, v67
v_dot2_f32_bf16 v84, v18, s98, v68
v_dot2_f32_bf16 v85, v18, s99, v69
v_dot2_f32_bf16 v86, v19, s98, v70
v_dot2_f32_bf16 v87, v19, s99, v71
v_xor_b32 v20, s4, v20
v_xor_b32 v21, s5, v21
v_xor_b32 v22, s6, v22
v_xor_b32 v23, s7, v23
v_or3_b32 v141, v20, v21, v141
v_or3_b32 v141, v22, v23, v141
v_dot2_f32_bf16 v80, v20, s98, v80
v_dot2_f32_bf16 v81, v20, s99, v81
v_dot2_f32_bf16 v82, v21, s98, v82
v_dot2_f32_bf16 v83, v21, s99, v83
v_dot2_f32_bf16 v84, v22, s98, v84
v_dot2_f32_bf16 v85, v22, s99, v85
v_dot2_f32_bf16 v86, v23, s98, v86
v_dot2_f32_bf16 v87, v23, s99, v87
v_xor_b32 v24, s4, v24
v_xor_b32 v25, s5, v25
v_xor_b32 v26, s6, v26
v_xor_b32 v27, s7, v27
v_or3_b32 v141, v24, v25, v141
v_or3_b32 v141, v26, v27, v141
v_dot2_f32_bf16 v80, v24, s98, v80
v_dot2_f32_bf16 v81, v24, s99, v81
v_dot2_f32_bf16 v82, v25, s98, v82
v_dot2_f32_bf16 v83, v25, s99, v83
v_dot2_f32_bf16 v84, v26, s98, v84
v_dot2_f32_bf16 v85, v26, s99, v85
v_dot2_f32_bf16 v86, v27, s98, v86
v_dot2_f32_bf16 v87, v27, s99, v87
v_xor_b32 v28, s4, v28
v_xor_b32 v29, s5, v29
v_xor_b32 v30, s6, v30
v_xor_b32 v31, s7, v31
v_or3_b32 v141, v28, v29, v141
v_or3_b32 v141, v30, v31, v141
v_dot2_f32_bf16 v80, v28, s98, v80
v_dot2_f32_bf16 v81, v28, s99, v81
v_dot2_f32_bf16 v82, v29, s98, v82
v_dot2_f32_bf16 v83, v29, s99, v83
v_dot2_f32_bf16 v84, v30, s98, v84
v_dot2_f32_bf16 v85, v30, s99, v85
v_dot2_f32_bf16 v86, v31, s98, v86
v_dot2_f32_bf16 v87, v31, s99, v87
v_xor_b32 v32, s4, v32
v_xor_b32 v33, s5, v33
v_xor_b32 v34, s6, v34
v_xor_b32 v35, s7, v35
v_or3_b32 v141, v32, v33, v141
v_or3_b32 v141, v34, v35, v141
v_dot2_f32_bf16 v80, v32, s98, v80
v_dot2_f32_bf16 v81, v32, s99, v81
v_dot2_f32_bf16 v82, v33, s98, v82
v_dot2_f32_bf16 v83, v33, s99, v83
v_dot2_f32_bf16 v84, v34, s98, v84
v_dot2_f32_bf16 v85, v34, s99, v85
v_dot2_f32_bf16 v86, v35, s98, v86
v_dot2_f32_bf16 v87, v35, s99, v87
v_xor_b32 v36, s4, v36
v_xor_b32 v37, s5, v37
v_xor_b32 v38, s6, v38
v_xor_b32 v39, s7, v39
v_or3_b32 v141, v36, v37, v141
v_or3_b32 v141, v38, v39, v141
v_and_b32 v141, v11, v141
v_cmp_ne_u32 vcc, 0, v141
v_dot2_f32_bf16 v80, v36, s98, v80
v_dot2_f32_bf16 v81, v36, s99, v81
v_dot2_f32_bf16 v82, v37, s98, v82
v_dot2_f32_bf16 v83, v37, s99, v83
v_dot2_f32_bf16 v84, v38, s98, v84
v_dot2_f32_bf16 v85, v38, s99, v85
v_dot2_f32_bf16 v86, v39, s98, v86
v_dot2_f32_bf16 v87, v39, s99, v87
s_cbranch_vccnz L_h4re
L_h4ok:
v_cvt_pk_bf16_f32 v80, v80, v81
v_cvt_pk_bf16_f32 v81, v82, v83
v_cvt_pk_bf16_f32 v82, v84, v85
v_cvt_pk_bf16_f32 v83, v86, v87
s_add_u32 s79, s90, 0
v_permlane16_swap_b32 v80, v82
v_permlane16_swap_b32 v81, v83
buffer_store_dwordx4 v[80:83], v14, s[48:51], s79 offen
s_waitcnt vmcnt(6)
v_xor_b32 v40, s4, v40
v_xor_b32 v41, s5, v41
v_xor_b32 v42, s6, v42
v_xor_b32 v43, s7, v43
v_or3_b32 v141, v40, v41, 0
v_or3_b32 v141, v42, v43, v141
v_dot2_f32_bf16 v88, v40, s98, v72
v_dot2_f32_bf16 v89, v40, s99, v73
v_dot2_f32_bf16 v90, v41, s98, v74
v_dot2_f32_bf16 v91, v41, s99, v75
v_dot2_f32_bf16 v92, v42, s98, v76
v_dot2_f32_bf16 v93, v42, s99, v77
v_dot2_f32_bf16 v94, v43, s98, v78
v_dot2_f32_bf16 v95, v43, s99, v79
s_waitcnt vmcnt(5)
v_xor_b32 v44, s4, v44
v_xor_b32 v45, s5, v45
v_xor_b32 v46, s6, v46
v_xor_b32 v47, s7, v47
v_or3_b32 v141, v44, v45, v141
v_or3_b32 v141, v46, v47, v141
v_dot2_f32_bf16 v88, v44, s98, v88
v_dot2_f32_bf16 v89, v44, s99, v89
v_dot2_f32_bf16 v90, v45, s98, v90
v_dot2_f32_bf16 v91, v45, s99, v91
v_dot2_f32_bf16 v92, v46, s98, v92
v_dot2_f32_bf16 v93, v46, s99, v93
v_dot2_f32_bf16 v94, v47, s98, v94
v_dot2_f32_bf16 v95, v47, s99, v95
s_waitcnt vmcnt(4)
v_xor_b32 v48, s4, v48
v_xor_b32 v49, s5, v49
v_xor_b32 v50, s6, v50
v_xor_b32 v51, s7, v51
v_or3_b32 v141, v48, v49, v141
v_or3_b32 v141, v50, v51, v141
v_dot2_f32_bf16 v88, v48, s98, v88
v_dot2_f32_bf16 v89, v48, s99, v89
v_dot2_f32_bf16 v90, v49, s98, v90
v_dot2_f32_bf16 v91, v49, s99, v91
v_dot2_f32_bf16 v92, v50, s98, v92
v_dot2_f32_bf16 v93, v50, s99, v93
v_dot2_f32_bf16 v94, v51, s98, v94
v_dot2_f32_bf16 v95, v51, s99, v95
s_waitcnt vmcnt(3)
v_xor_b32 v52, s4, v52
v_xor_b32 v53, s5, v53
v_xor_b32 v54, s6, v54
v_xor_b32 v55, s7, v55
v_or3_b32 v141, v52, v53, v141
v_or3_b32 v141, v54, v55, v141
v_dot2_f32_bf16 v88, v52, s98, v88
v_dot2_f32_bf16 v89, v52, s99, v89
v_dot2_f32_bf16 v90, v53, s98, v90
v_dot2_f32_bf16 v91, v53, s99, v91
v_dot2_f32_bf16 v92, v54, s98, v92
v_dot2_f32_bf16 v93, v54, s99, v93
v_dot2_f32_bf16 v94, v55, s98, v94
v_dot2_f32_bf16 v95, v55, s99, v95
s_waitcnt vmcnt(2)
v_xor_b32 v56, s4, v56
v_xor_b32 v57, s5, v57
v_xor_b32 v58, s6, v58
v_xor_b32 v59, s7, v59
v_or3_b32 v141, v56, v57, v141
v_or3_b32 v141, v58, v59, v141
v_dot2_f32_bf16 v88, v56, s98, v88
v_dot2_f32_bf16 v89, v56, s99, v89
v_dot2_f32_bf16 v90, v57, s98, v90
v_dot2_f32_bf16 v91, v57, s99, v91
v_dot2_f32_bf16 v92, v58, s98, v92
v_dot2_f32_bf16 v93, v58, s99, v93
v_dot2_f32_bf16 v94, v59, s98, v94
v_dot2_f32_bf16 v95, v59, s99, v95
s_waitcnt vmcnt(1)
v_xor_b32 v60, s4, v60
v_xor_b32 v61, s5, v61
v_xor_b32 v62, s6, v62
v_xor_b32 v63, s7, v63
v_or3_b32 v141, v60, v61, v141
v_or3_b32 v141, v62, v63, v141
v_and_b32 v141, v11, v141
v_cmp_ne_u32 vcc, 0, v141
v_dot2_f32_bf16 v88, v60, s98, v88
v_dot2_f32_bf16 v89, v60, s99, v89
v_dot2_f32_bf16 v90, v61, s98, v90
v_dot2_f32_bf16 v91, v61, s99, v91
v_dot2_f32_bf16 v92, v62, s98, v92
v_dot2_f32_bf16 v93, v62, s99, v93
v_dot2_f32_bf16 v94, v63, s98, v94
v_dot2_f32_bf16 v95, v63, s99, v95
s_cbranch_vccnz L_h3re
L_h3ok:
v_cvt_pk_bf16_f32 v88, v88, v89
v_cvt_pk_bf16_f32 v89, v90, v91
v_cvt_pk_bf16_f32 v90, v92, v93
v_cvt_pk_bf16_f32 v91, v94, v95
s_add_u32 s79, s90, 28672
v_permlane16_swap_b32 v88, v90
v_permlane16_swap_b32 v89, v91
buffer_store_dwordx4 v[88:91], v14, s[48:51], s79 offen
s_endpgm
L_h1re:
s_add_u32 s68, s68, 1
s_cmp_ge_u32 s68, 20000
s_cbranch_scc1 L_h1ok
s_add_u32 s60, s74, 0
buffer_load_dwordx4 v[16:19], v11, s[36:39], s60 offen sc1
s_mov_b32 s60, 4096
buffer_load_dwordx4 v[32:35], v11, s[36:39], s60 offen sc1
s_add_u32 s60, s74, 4096
buffer_load_dwordx4 v[20:23], v11, s[36:39], s60 offen sc1
s_mov_b32 s60, 8192
buffer_load_dwordx4 v[36:39], v11, s[36:39], s60 offen sc1
s_add_u32 s60, s74, 8192
buffer_load_dwordx4 v[24:27], v11, s[36:39], s60 offen sc1
s_mov_b32 s60, 12288
buffer_load_dwordx4 v[40:43], v11, s[36:39], s60 offen sc1
s_add_u32 s60, s74, 12288
buffer_load_dwordx4 v[28:31], v11, s[36:39], s60 offen sc1
s_mov_b32 s60, 16384
buffer_load_dwordx4 v[44:47], v11, s[36:39], s60 offen sc1
s_branch L_h1
L_h2re:
s_add_u32 s68, s68, 1
s_cmp_ge_u32 s68, 20000
s_cbranch_scc1 L_h2ok
s_add_u32 m0, s88, 0
s_add_u32 s79, s89, 0
buffer_load_dwordx4 v10, s[36:39], s79 offen offset:0 sc1 lds
buffer_load_dwordx4 v10, s[36:39], s79 offen offset:1024 sc1 lds
buffer_load_dwordx4 v10, s[36:39], s79 offen offset:2048 sc1 lds
buffer_load_dwordx4 v10, s[36:39], s79 offen offset:3072 sc1 lds
s_add_u32 m0, s88, 4096
s_add_u32 s79, s89, 4096
buffer_load_dwordx4 v10, s[36:39], s79 offen offset:0 sc1 lds
buffer_load_dwordx4 v10, s[36:39], s79 offen offset:1024 sc1 lds
buffer_load_dwordx4 v10, s[36:39], s79 offen offset:2048 sc1 lds
buffer_load_dwordx4 v10, s[36:39], s79 offen offset:3072 sc1 lds
s_add_u32 m0, s88, 8192
s_add_u32 s79, s89, 8192
buffer_load_dwordx4 v10, s[36:39], s79 offen offset:0 sc1 lds
buffer_load_dwordx4 v10, s[36:39], s79 offen offset:1024 sc1 lds
buffer_load_dwordx4 v10, s[36:39], s79 offen offset:2048 sc1 lds
buffer_load_dwordx4 v10, s[36:39], s79 offen offset:3072 sc1 lds
s_add_u32 m0, s88, 12288
s_add_u32 s79, s89, 12288
buffer_load_dwordx4 v10, s[36:39], s79 offen offset:0 sc1 lds
buffer_load_dwordx4 v10, s[36:39], s79 offen offset:1024 sc1 lds
s_branch L_h2
L_h4re:
s_add_u32 s68, s68, 1
s_cmp_ge_u32 s68, 20000
s_cbranch_scc1 L_h4ok
buffer_load_dwordx4 v[16:19], v10, s[36:39], s92 offen offset:0 sc1
buffer_load_dwordx4 v[20:23], v10, s[36:39], s93 offen offset:0 sc1
buffer_load_dwordx4 v[24:27], v10, s[36:39], s94 offen offset:0 sc1
buffer_load_dwordx4 v[28:31], v10, s[36:39], s95 offen offset:0 sc1
buffer_load_dwordx4 v[32:35], v10, s[36:39], s96 offen offset:0 sc1
buffer_load_dwordx4 v[36:39], v10, s[36:39], s97 offen offset:0 sc1
s_waitcnt vmcnt(0)
v_xor_b32 v16, s4, v16
v_xor_b32 v17, s5, v17
v_xor_b32 v18, s6, v18
v_xor_b32 v19, s7, v19
v_or3_b32 v141, v16, v17, 0
v_or3_b32 v141, v18, v19, v141
v_dot2_f32_bf16 v80, v16, s98, v64
v_dot2_f32_bf16 v81, v16, s99, v65
v_dot2_f32_bf16 v82, v17, s98, v66
v_dot2_f32_bf16 v83, v17, s99, v67
v_dot2_f32_bf16 v84, v18, s98, v68
v_dot2_f32_bf16 v85, v18, s99, v69
v_dot2_f32_bf16 v86, v19, s98, v70
v_dot2_f32_bf16 v87, v19, s99, v71
v_xor_b32 v20, s4, v20
v_xor_b32 v21, s5, v21
v_xor_b32 v22, s6, v22
v_xor_b32 v23, s7, v23
v_or3_b32 v141, v20, v21, v141
v_or3_b32 v141, v22, v23, v141
v_dot2_f32_bf16 v80, v20, s98, v80
v_dot2_f32_bf16 v81, v20, s99, v81
v_dot2_f32_bf16 v82, v21, s98, v82
v_dot2_f32_bf16 v83, v21, s99, v83
v_dot2_f32_bf16 v84, v22, s98, v84
v_dot2_f32_bf16 v85, v22, s99, v85
v_dot2_f32_bf16 v86, v23, s98, v86
v_dot2_f32_bf16 v87, v23, s99, v87
v_xor_b32 v24, s4, v24
v_xor_b32 v25, s5, v25
v_xor_b32 v26, s6, v26
v_xor_b32 v27, s7, v27
v_or3_b32 v141, v24, v25, v141
v_or3_b32 v141, v26, v27, v141
v_dot2_f32_bf16 v80, v24, s98, v80
v_dot2_f32_bf16 v81, v24, s99, v81
v_dot2_f32_bf16 v82, v25, s98, v82
v_dot2_f32_bf16 v83, v25, s99, v83
v_dot2_f32_bf16 v84, v26, s98, v84
v_dot2_f32_bf16 v85, v26, s99, v85
v_dot2_f32_bf16 v86, v27, s98, v86
v_dot2_f32_bf16 v87, v27, s99, v87
v_xor_b32 v28, s4, v28
v_xor_b32 v29, s5, v29
v_xor_b32 v30, s6, v30
v_xor_b32 v31, s7, v31
v_or3_b32 v141, v28, v29, v141
v_or3_b32 v141, v30, v31, v141
v_dot2_f32_bf16 v80, v28, s98, v80
v_dot2_f32_bf16 v81, v28, s99, v81
v_dot2_f32_bf16 v82, v29, s98, v82
v_dot2_f32_bf16 v83, v29, s99, v83
v_dot2_f32_bf16 v84, v30, s98, v84
v_dot2_f32_bf16 v85, v30, s99, v85
v_dot2_f32_bf16 v86, v31, s98, v86
v_dot2_f32_bf16 v87, v31, s99, v87
v_xor_b32 v32, s4, v32
v_xor_b32 v33, s5, v33
v_xor_b32 v34, s6, v34
v_xor_b32 v35, s7, v35
v_or3_b32 v141, v32, v33, v141
v_or3_b32 v141, v34, v35, v141
v_dot2_f32_bf16 v80, v32, s98, v80
v_dot2_f32_bf16 v81, v32, s99, v81
v_dot2_f32_bf16 v82, v33, s98, v82
v_dot2_f32_bf16 v83, v33, s99, v83
v_dot2_f32_bf16 v84, v34, s98, v84
v_dot2_f32_bf16 v85, v34, s99, v85
v_dot2_f32_bf16 v86, v35, s98, v86
v_dot2_f32_bf16 v87, v35, s99, v87
v_xor_b32 v36, s4, v36
v_xor_b32 v37, s5, v37
v_xor_b32 v38, s6, v38
v_xor_b32 v39, s7, v39
v_or3_b32 v141, v36, v37, v141
v_or3_b32 v141, v38, v39, v141
v_and_b32 v141, v11, v141
v_cmp_ne_u32 vcc, 0, v141
v_dot2_f32_bf16 v80, v36, s98, v80
v_dot2_f32_bf16 v81, v36, s99, v81
v_dot2_f32_bf16 v82, v37, s98, v82
v_dot2_f32_bf16 v83, v37, s99, v83
v_dot2_f32_bf16 v84, v38, s98, v84
v_dot2_f32_bf16 v85, v38, s99, v85
v_dot2_f32_bf16 v86, v39, s98, v86
v_dot2_f32_bf16 v87, v39, s99, v87
s_cbranch_vccnz L_h4re
s_branch L_h4ok
L_h3re:
s_add_u32 s68, s68, 1
s_cmp_ge_u32 s68, 20000
s_cbranch_scc1 L_h3ok
buffer_load_dwordx4 v[40:43], v10, s[36:39], s92 offen offset:1024 sc1
buffer_load_dwordx4 v[44:47], v10, s[36:39], s93 offen offset:1024 sc1
buffer_load_dwordx4 v[48:51], v10, s[36:39], s94 offen offset:1024 sc1
buffer_load_dwordx4 v[52:55], v10, s[36:39], s95 offen offset:1024 sc1
buffer_load_dwordx4 v[56:59], v10, s[36:39], s96 offen offset:1024 sc1
buffer_load_dwordx4 v[60:63], v10, s[36:39], s97 offen offset:1024 sc1
s_waitcnt vmcnt(0)
v_xor_b32 v40, s4, v40
v_xor_b32 v41, s5, v41
v_xor_b32 v42, s6, v42
v_xor_b32 v43, s7, v43
v_or3_b32 v141, v40, v41, 0
v_or3_b32 v141, v42, v43, v141
v_dot2_f32_bf16 v88, v40, s98, v72
v_dot2_f32_bf16 v89, v40, s99, v73
v_dot2_f32_bf16 v90, v41, s98, v74
v_dot2_f32_bf16 v91, v41, s99, v75
v_dot2_f32_bf16 v92, v42, s98, v76
v_dot2_f32_bf16 v93, v42, s99, v77
v_dot2_f32_bf16 v94, v43, s98, v78
v_dot2_f32_bf16 v95, v43, s99, v79
v_xor_b32 v44, s4, v44
v_xor_b32 v45, s5, v45
v_xor_b32 v46, s6, v46
v_xor_b32 v47, s7, v47
v_or3_b32 v141, v44, v45, v141
v_or3_b32 v141, v46, v47, v141
v_dot2_f32_bf16 v88, v44, s98, v88
v_dot2_f32_bf16 v89, v44, s99, v89
v_dot2_f32_bf16 v90, v45, s98, v90
v_dot2_f32_bf16 v91, v45, s99, v91
v_dot2_f32_bf16 v92, v46, s98, v92
v_dot2_f32_bf16 v93, v46, s99, v93
v_dot2_f32_bf16 v94, v47, s98, v94
v_dot2_f32_bf16 v95, v47, s99, v95
v_xor_b32 v48, s4, v48
v_xor_b32 v49, s5, v49
v_xor_b32 v50, s6, v50
v_xor_b32 v51, s7, v51
v_or3_b32 v141, v48, v49, v141
v_or3_b32 v141, v50, v51, v141
v_dot2_f32_bf16 v88, v48, s98, v88
v_dot2_f32_bf16 v89, v48, s99, v89
v_dot2_f32_bf16 v90, v49, s98, v90
v_dot2_f32_bf16 v91, v49, s99, v91
v_dot2_f32_bf16 v92, v50, s98, v92
v_dot2_f32_bf16 v93, v50, s99, v93
v_dot2_f32_bf16 v94, v51, s98, v94
v_dot2_f32_bf16 v95, v51, s99, v95
v_xor_b32 v52, s4, v52
v_xor_b32 v53, s5, v53
v_xor_b32 v54, s6, v54
v_xor_b32 v55, s7, v55
v_or3_b32 v141, v52, v53, v141
v_or3_b32 v141, v54, v55, v141
v_dot2_f32_bf16 v88, v52, s98, v88
v_dot2_f32_bf16 v89, v52, s99, v89
v_dot2_f32_bf16 v90, v53, s98, v90
v_dot2_f32_bf16 v91, v53, s99, v91
v_dot2_f32_bf16 v92, v54, s98, v92
v_dot2_f32_bf16 v93, v54, s99, v93
v_dot2_f32_bf16 v94, v55, s98, v94
v_dot2_f32_bf16 v95, v55, s99, v95
v_xor_b32 v56, s4, v56
v_xor_b32 v57, s5, v57
v_xor_b32 v58, s6, v58
v_xor_b32 v59, s7, v59
v_or3_b32 v141, v56, v57, v141
v_or3_b32 v141, v58, v59, v141
v_dot2_f32_bf16 v88, v56, s98, v88
v_dot2_f32_bf16 v89, v56, s99, v89
v_dot2_f32_bf16 v90, v57, s98, v90
v_dot2_f32_bf16 v91, v57, s99, v91
v_dot2_f32_bf16 v92, v58, s98, v92
v_dot2_f32_bf16 v93, v58, s99, v93
v_dot2_f32_bf16 v94, v59, s98, v94
v_dot2_f32_bf16 v95, v59, s99, v95
v_xor_b32 v60, s4, v60
v_xor_b32 v61, s5, v61
v_xor_b32 v62, s6, v62
v_xor_b32 v63, s7, v63
v_or3_b32 v141, v60, v61, v141
v_or3_b32 v141, v62, v63, v141
v_and_b32 v141, v11, v141
v_cmp_ne_u32 vcc, 0, v141
v_dot2_f32_bf16 v88, v60, s98, v88
v_dot2_f32_bf16 v89, v60, s99, v89
v_dot2_f32_bf16 v90, v61, s98, v90
v_dot2_f32_bf16 v91, v61, s99, v91
v_dot2_f32_bf16 v92, v62, s98, v92
v_dot2_f32_bf16 v93, v62, s99, v93
v_dot2_f32_bf16 v94, v63, s98, v94
v_dot2_f32_bf16 v95, v63, s99, v95
s_cbranch_vccnz L_h3re
s_branch L_h3ok
L_helper:
v_lshlrev_b32 v3, 7, v1
s_lshr_b32 s78, s66, 1
s_mul_i32 s78, s78, 212992
s_lshl_b32 s79, s66, 13
s_add_u32 s78, s78, s79
buffer_store_dwordx4 v[52:55], v11, s[36:39], s76 offen sc1
buffer_store_dwordx4 v[52:55], v93, s[36:39], s76 offen sc1
s_waitcnt vmcnt(2) lgkmcnt(0)
s_add_u32 s35, s35, 1
v_mov_b32 v2, s35
v_pk_mov_b32 v[18:19], v[2:3], v[2:3] op_sel:[0,0]
v_pk_mov_b32 v[22:23], v[2:3], v[2:3] op_sel:[0,0]
v_pk_mov_b32 v[26:27], v[2:3], v[2:3] op_sel:[0,0]
v_pk_mov_b32 v[30:31], v[2:3], v[2:3] op_sel:[0,0]
v_pk_mov_b32 v[16:17], v[112:113], v[124:125] op_sel:[0,0]
v_pk_mov_b32 v[20:21], v[112:113], v[124:125] op_sel:[1,1]
v_pk_mov_b32 v[24:25], v[114:115], v[126:127] op_sel:[0,0]
v_pk_mov_b32 v[28:29], v[114:115], v[126:127] op_sel:[1,1]
s_add_u32 s60, s74, 65536
buffer_store_dwordx4 v[16:19], v8, s[36:39], s60 offen sc1
s_add_u32 s60, s74, 82176
buffer_store_dwordx4 v[20:23], v8, s[36:39], s60 offen sc1
s_add_u32 s60, s74, 98816
buffer_store_dwordx4 v[24:27], v8, s[36:39], s60 offen sc1
s_add_u32 s60, s74, 115456
buffer_store_dwordx4 v[28:31], v8, s[36:39], s60 offen sc1
s_lshl_b32 s61, s2, 6
v_dot2_f32_bf16 v116, v32, s62, 0
v_dot2_f32_bf16 v117, v32, v32, 0
v_dot2_f32_bf16 v116, v33, s62, v116
v_dot2_f32_bf16 v117, v33, v33, v117
v_dot2_f32_bf16 v116, v34, s62, v116
v_dot2_f32_bf16 v117, v34, v34, v117
v_dot2_f32_bf16 v116, v35, s62, v116
v_dot2_f32_bf16 v117, v35, v35, v117
v_dot2_f32_bf16 v116, v36, s62, v116
v_dot2_f32_bf16 v117, v36, v36, v117
v_dot2_f32_bf16 v116, v37, s62, v116
v_dot2_f32_bf16 v117, v37, v37, v117
v_dot2_f32_bf16 v116, v38, s62, v116
v_dot2_f32_bf16 v117, v38, v38, v117
s_nop 1
v_add_f32_dpp v116, v116, v116 quad_perm:[1,0,3,2] row_mask:0xf bank_mask:0xf
v_add_f32_dpp v117, v117, v117 quad_perm:[1,0,3,2] row_mask:0xf bank_mask:0xf
s_lshl_b32 s60, s34, 4
v_add_f32_dpp v116, v116, v116 quad_perm:[2,3,0,1] row_mask:0xf bank_mask:0xf
v_add_f32_dpp v117, v117, v117 quad_perm:[2,3,0,1] row_mask:0xf bank_mask:0xf
s_add_u32 s60, s60, s61
v_add_f32_dpp v116, v116, v116 row_half_mirror row_mask:0xf bank_mask:0xf
v_add_f32_dpp v117, v117, v117 row_half_mirror row_mask:0xf bank_mask:0xf
s_add_u32 s60, s60, 4096
v_add_f32_dpp v116, v116, v116 row_mirror row_mask:0xf bank_mask:0xf
v_add_f32_dpp v117, v117, v117 row_mirror row_mask:0xf bank_mask:0xf
v_mov_b32 v35, v2
v_pk_mov_b32 v[32:33], v[116:117], v[116:117] op_sel:[0,1]
v_lshlrev_b32 v118, 25, v1
s_nop 0
v_permlane16_swap_b32 v32, v116
v_permlane16_swap_b32 v33, v117
v_pk_add_f32 v[116:117], v[116:117], v[32:33]
v_mul_f32 v116, 0x3b124925, v116
v_mul_f32 v117, 0x3b124925, v117
v_fma_f32 v117, -v116, v116, v117
v_max_f32 v117, 0, v117
v_cvt_pk_bf16_f32 v34, v116, v117
v_and_b32 v117, s65, v34
v_add_f32 v117, 0x3727c5ac, v117
v_cvt_pk_bf16_f32 v117, v117, v117
v_and_b32 v117, s65, v117
v_sqrt_f32 v117, v117
v_mov_b32 v116, v34
v_cvt_pk_bf16_f32 v117, v117, v117
v_and_b32 v117, s65, v117
v_rcp_f32 v32, v117
v_permlane32_swap_b32 v34, v116
v_mov_b32 v33, v32
v_and_b32 v34, 0xffff, v34
v_lshl_or_b32 v34, v116, 16, v34
v_permlane32_swap_b32 v32, v33
s_waitcnt vmcnt(4)
buffer_store_dwordx4 v[32:35], v118, s[36:39], s60 offen sc1
s_waitcnt vmcnt(0)
v_min_u32 v4, 3456, v3
v_min_u32 v5, 768, v3
global_load_dword v62, v4, s[22:23]
global_load_dword v63, v5, s[26:27]
buffer_load_dword v78, v3, s[44:47], s78 offen
s_add_u32 s78, s78, 16384
buffer_load_dword v79, v3, s[44:47], s78 offen
s_add_u32 s78, s78, 16384
buffer_load_dword v80, v3, s[44:47], s78 offen
s_add_u32 s78, s78, 16384
buffer_load_dword v81, v3, s[44:47], s78 offen
s_add_u32 s78, s78, 16384
buffer_load_dword v82, v3, s[44:47], s78 offen
s_add_u32 s78, s78, 16384
buffer_load_dword v83, v3, s[44:47], s78 offen
s_add_u32 s78, s78, 16384
buffer_load_dword v84, v3, s[44:47], s78 offen
s_add_u32 s78, s78, 16384
buffer_load_dword v85, v3, s[44:47], s78 offen
s_add_u32 s78, s78, 16384
buffer_load_dword v86, v3, s[44:47], s78 offen
s_add_u32 s78, s78, 16384
buffer_load_dword v87, v3, s[44:47], s78 offen
s_add_u32 s78, s78, 16384
buffer_load_dword v88, v3, s[44:47], s78 offen
s_add_u32 s78, s78, 16384
buffer_load_dword v89, v3, s[44:47], s78 offen
s_add_u32 s78, s78, 16384
buffer_load_dword v90, v3, s[44:47], s78 offen
s_add_u32 s78, s78, 16384
buffer_load_dword v91, v3, s[44:47], s78 offen
s_add_u32 s78, s78, 16384
L_end:
s_endpgm

.section .rodata,"a"
.p2align 6
.amdhsa_kernel sequential_preLN__ssm_conv_s4d__mixer_channel_mlp__prompt_kernel
  .amdhsa_next_free_vgpr 512
  .amdhsa_next_free_sgpr 102
  .amdhsa_accum_offset 256
  .amdhsa_group_segment_fixed_size 0
  .amdhsa_kernarg_size 120
  .amdhsa_user_sgpr_count 2
  .amdhsa_user_sgpr_kernarg_segment_ptr 1
  .amdhsa_system_sgpr_workgroup_id_x 1
.end_amdhsa_kernel
```
